```python
import torch

def _softmax(x, axis=-1):
    return torch.softmax(x, dim=axis)
def _gelu(x):
    return torch.nn.functional.gelu(x, approximate="tanh")
def _silu(x):
    return torch.nn.functional.silu(x)
def _sigmoid(x):
    return torch.sigmoid(x)
def _layernorm(x, axis=-1, eps=1e-5):
    m = x.mean(dim=axis, keepdim=True)
    v = x.var(dim=axis, keepdim=True, unbiased=False)
    return (x - m) / torch.sqrt(v + eps)
def _scatter_add(tgt, idx, src, axis=0):
    return tgt.clone().index_add_(axis, idx, src)
def _segment_sum(src, seg, n):
    out = torch.zeros((n,) + src.shape[1:], dtype=src.dtype)
    return out.index_add_(0, seg, src)
def _pad(x, pw):
    flat = tuple(v for pair in reversed(pw) for v in pair)
    return torch.nn.functional.pad(x, flat)

kernel_name = 'concat_heads__gqa_block_cached__sliding_block_cached__decode'

def setup_inputs():

    _w = (lambda a: (lambda t: t.to(torch.bfloat16) if t.is_floating_point() else t)(torch.as_tensor(a)))
    def _A_setup():
        B, Sq, D = 1, 1, 512
        Hq, Hkv, Sk, Dh = 32, 8, 65536, 128
        assert Hq % Hkv == 0, (Hq, Hkv)
        return {
            "x": _w((lambda *s: torch.randn(*s, dtype=torch.bfloat16) * 0.4)(B, Sq, D)),
            "k_cache": _w((lambda *s: torch.randn(*s, dtype=torch.bfloat16) * 3.2)(B, Hkv, Sk, Dh)),
            "v_cache": _w((lambda *s: torch.randn(*s, dtype=torch.bfloat16) * 0.8)(B, Hkv, Sk, Dh)),
            "wq": _w((lambda *s: torch.randn(*s, dtype=torch.bfloat16) * 3.2)(D, Hq * Dh) * (D ** -0.5)),
            "wo": _w((lambda *s: torch.randn(*s, dtype=torch.bfloat16) * 0.8)(Hq * Dh, D) * ((Hq * Dh) ** -0.5)),
        }
    _A_in = _A_setup()

    def _B_setup():
        B, Sq, D = 1, 1, 512
        Hq, Hkv, Sk, Dh = 32, 8, 65536, 128
        assert Hq % Hkv == 0, (Hq, Hkv)
        return {
            "x": _w((lambda *s: torch.randn(*s, dtype=torch.bfloat16) * 0.2)(B, Sq, D)),
            "k_cache": _w((lambda *s: torch.randn(*s, dtype=torch.bfloat16) * 3.2)(B, Hkv, Sk, Dh)),
            "v_cache": _w((lambda *s: torch.randn(*s, dtype=torch.bfloat16) * 1.6)(B, Hkv, Sk, Dh)),
            "wq": _w((lambda *s: torch.randn(*s, dtype=torch.bfloat16) * 3.2)(D, Hq * Dh) * (D ** -0.5)),
            "wo": _w((lambda *s: torch.randn(*s, dtype=torch.bfloat16) * 1.6)(Hq * Dh, D) * ((Hq * Dh) ** -0.5)),
        }
    _B_in = _B_setup()

    return {
        "A_x": _A_in["x"],
        "A_k_cache": _A_in["k_cache"],
        "A_v_cache": _A_in["v_cache"],
        "A_wq": _A_in["wq"],
        "A_wo": _A_in["wo"],
        "B_x": _B_in["x"],
        "B_k_cache": _B_in["k_cache"],
        "B_v_cache": _B_in["v_cache"],
        "B_wq": _B_in["wq"],
        "B_wo": _B_in["wo"],
    }

def reference(A_x, A_k_cache, A_v_cache, A_wq, A_wo, B_x, B_k_cache, B_v_cache, B_wq, B_wo):
    def _A_ref(x, k_cache, v_cache, wq, wo):
        B, Sq, D = x.shape
        Hq, Dh = 32, 128
        Hkv = k_cache.shape[1]
        rep = Hq // Hkv
        q = (lambda x, *d: x.permute(*d))((x @ wq).reshape(B, Sq, Hq, Dh), 0, 2, 1, 3)
        k = (lambda x, n, axis: torch.repeat_interleave(x, n, dim=axis))(k_cache, rep, axis=1)
        v = (lambda x, n, axis: torch.repeat_interleave(x, n, dim=axis))(v_cache, rep, axis=1)
        scores = torch.einsum("bhqd,bhkd->bhqk", q, k) * (Dh ** -0.5)
        p = _softmax(scores, axis=-1)
        o = torch.einsum("bhqk,bhkd->bhqd", p, v)
        return (lambda x, *d: x.permute(*d))(o, 0, 2, 1, 3).reshape(B, Sq, Hq * Dh) @ wo

    def _B_ref(x, k_cache, v_cache, wq, wo):
        B, Sq, D = x.shape
        Hq, Dh = 32, 128
        Hkv, Sk = k_cache.shape[1], k_cache.shape[2]
        W = min(4096, max(256, Sk // 4))
        rep = Hq // Hkv
        q = (lambda x, *d: x.permute(*d))((x @ wq).reshape(B, Sq, Hq, Dh), 0, 2, 1, 3)
        k = (lambda x, n, axis: torch.repeat_interleave(x, n, dim=axis))(k_cache[:, :, Sk - W:, :], rep, axis=1)
        v = (lambda x, n, axis: torch.repeat_interleave(x, n, dim=axis))(v_cache[:, :, Sk - W:, :], rep, axis=1)
        scores = torch.einsum("bhqd,bhkd->bhqk", q, k) * (Dh ** -0.5)
        p = _softmax(scores, axis=-1)
        o = torch.einsum("bhqk,bhkd->bhqd", p, v)
        return (lambda x, *d: x.permute(*d))(o, 0, 2, 1, 3).reshape(B, Sq, Hq * Dh) @ wo

    a = _A_ref(A_x, A_k_cache, A_v_cache, A_wq, A_wo)
    b = _B_ref(B_x, B_k_cache, B_v_cache, B_wq, B_wo)
    return torch.concatenate([a, b], axis=-1)
```

```asm
; @launch grid=(256,1,1) block=(512,1,1) lds=53248
.amdgcn_target "amdgcn-amd-amdhsa--gfx950"
.text
.globl concat_heads__gqa_block_cached__sliding_block_cached__decode_kernel
.p2align 8
.type concat_heads__gqa_block_cached__sliding_block_cached__decode_kernel,@function
concat_heads__gqa_block_cached__sliding_block_cached__decode_kernel:
    s_cmp_ge_u32 s2, 256
    s_cbranch_scc1 L_end
    s_load_dwordx16 s[4:19], s[0:1], 0
    s_load_dwordx8 s[20:27], s[0:1], 64
    s_load_dwordx2 s[28:29], s[0:1], 96
    v_lshrrev_b32 v1, 6, v0
    v_and_b32 v0, 63, v0
    v_readfirstlane_b32 s64, v1
    s_lshr_b32 s65, s2, 5
    s_and_b32 s66, s2, 31
    s_sub_u32 s67, s66, s65
    s_and_b32 s67, s67, 31
    s_and_b32 s79, s66, 7
    s_lshl_b32 s79, s79, 1
    s_bfe_u32 s72, s66, 0x10003
    s_or_b32 s79, s79, s72
    s_lshl_b32 s71, s64, 19
    s_lshl_b32 s72, s65, 10
    s_add_u32 s71, s71, s72
    s_lshl_b32 s72, s79, 6
    s_add_u32 s71, s71, s72
    s_lshl_b32 s78, s64, 7
    v_lshrrev_b32 v4, 2, v0
    v_lshlrev_b32 v5, 3, v4
    v_lshlrev_b32 v4, 15, v4
    v_and_b32 v6, 3, v0
    v_lshlrev_b32 v7, 4, v6
    v_or_b32 v4, v4, v7
    v_lshlrev_b32 v1, 10, v6
    v_bfe_u32 v7, v0, 2, 2
    v_lshlrev_b32 v7, 8, v7
    v_or_b32 v1, v1, v7
    v_and_b32 v7, 48, v0
    v_or_b32 v1, v1, v7
    v_lshlrev_b32 v2, 4, v0
    v_mov_b32 v3, 0
    s_mul_i32 s88, s67, 124
    s_mov_b32 s89, 124
    s_mov_b32 s91, 0x1000000
    s_mov_b32 s69, 3908
    s_mov_b32 s90, 0
    s_cmp_ge_u32 s67, 15
    s_cselect_b32 s69, 4096, s69
    s_cselect_b32 s90, 256, s90
    s_lshl_b32 s92, s65, 10
    s_add_u32 s92, s92, 57344
    s_add_u32 s90, s90, s92
    s_cmp_ge_u32 s67, 30
    s_cbranch_scc0 L_isA
    s_sub_u32 s88, s67, 30
    s_lshl_b32 s88, s88, 7
    s_add_u32 s88, s88, 3840
    s_add_u32 s69, s88, 128
    s_mov_b32 s89, 0x7fffffff
    s_lshl_b32 s91, s69, 12
L_isA:
    s_lshl_b32 s68, s88, 12
    s_lshl_b32 s69, s69, 12
    s_mov_b32 s43, 0x20000
    s_mov_b32 s42, 0x400000
    s_mov_b32 s47, 0x20000
    s_mov_b32 s46, 1024
    s_mov_b32 s35, 0x20000
    s_mov_b32 s39, 0x20000
    s_mov_b32 s34, s91
    s_mov_b32 s38, s91
    s_mov_b32 s55, 0x20000
    s_mov_b32 s54, 5242880
    s_lshl_b32 s3, s65, 24
    s_lshl_b32 s70, s64, 12
    s_add_u32 s70, s70, s68
    s_add_u32 s80, s71, 8192
    s_add_u32 s81, s71, 16384
    s_add_u32 s82, s71, 24576
    s_lshl_b32 s84, s65, 5
    s_add_u32 s84, s84, s67
    s_lshl_b32 s84, s84, 12
    s_add_u32 s84, s84, 65536
    s_lshr_b32 s85, s66, 4
    s_lshl_b32 s85, s85, 18
    s_lshl_b32 s72, s65, 8
    s_add_u32 s85, s85, s72
    s_and_b32 s72, s66, 15
    s_lshl_b32 s72, s72, 4
    s_add_u32 s85, s85, s72
    s_add_u32 s85, s85, 2097152
    s_lshl_b32 s87, s65, 12
    s_lshl_b32 s72, s67, 4
    s_add_u32 s87, s87, s72
    s_cmp_ge_u32 s67, 30
    s_cselect_b32 s72, 1568, 0
    s_add_u32 s87, s87, s72
    s_add_u32 s87, s87, 1572864
    s_setprio 2
    s_cmp_ge_u32 s66, 16
    s_waitcnt lgkmcnt(0)
    s_cselect_b32 s44, s14, s4
    s_cselect_b32 s45, s15, s5
    s_cselect_b32 s40, s20, s10
    s_cselect_b32 s41, s21, s11
    s_cselect_b32 s48, s22, s12
    s_cselect_b32 s49, s23, s13
    s_mov_b32 s52, s28
    s_mov_b32 s53, s29
    s_cmp_eq_u32 s64, 7
    s_cbranch_scc0 L_noep
    buffer_load_dword v126, v3, s[52:55], 0 offen sc1
    s_cmp_lt_u32 s66, 2
    s_cbranch_scc0 L_noep
    s_mov_b32 s73, 3720
    s_cmp_eq_u32 s66, 1
    s_cselect_b32 s73, 3908, s73
    v_mov_b32 v8, s73
    s_lshl_b32 s73, s66, 8
    s_add_u32 s73, s73, s92
    s_mov_b64 exec, 1
    buffer_store_dword v8, v3, s[52:55], s73 offen sc1
    s_mov_b64 exec, -1
L_noep:
    buffer_load_dwordx2 v[120:121], v5, s[44:47], s78 offen
    buffer_load_dwordx4 v[104:107], v4, s[40:43], s71 offen nt
    buffer_load_dwordx4 v[108:111], v4, s[40:43], s80 offen nt
    buffer_load_dwordx4 v[112:115], v4, s[40:43], s81 offen nt
    buffer_load_dwordx4 v[116:119], v4, s[40:43], s82 offen nt
    s_cmp_ge_u32 s67, 30
    s_cselect_b32 s32, s16, s6
    s_cselect_b32 s33, s17, s7
    s_cselect_b32 s36, s18, s8
    s_cselect_b32 s37, s19, s9
    s_add_u32 s32, s32, s3
    s_addc_u32 s33, s33, 0
    s_add_u32 s36, s36, s3
    s_addc_u32 s37, s37, 0
    s_barrier
    s_cmp_eq_u32 s64, 7
    s_cbranch_scc1 L_w7a
    buffer_load_dwordx4 v[128:131], v1, s[32:35], s70 offen offset:0 nt
    buffer_load_dwordx4 v[132:135], v1, s[32:35], s70 offen offset:64 nt
    buffer_load_dwordx4 v[136:139], v1, s[32:35], s70 offen offset:128 nt
    buffer_load_dwordx4 v[140:143], v1, s[32:35], s70 offen offset:192 nt
    buffer_load_dwordx4 v[144:147], v2, s[36:39], s70 offen offset:0 nt
    buffer_load_dwordx4 v[148:151], v2, s[36:39], s70 offen offset:1024 nt
    buffer_load_dwordx4 v[152:155], v2, s[36:39], s70 offen offset:2048 nt
    buffer_load_dwordx4 v[156:159], v2, s[36:39], s70 offen offset:3072 nt
    s_branch L_w7b
L_w7a:
    v_mov_b32 v52, 29
    ds_write_b32 v3, v52
    ds_write_b32 v3, v3 offset:8
L_w7b:
    s_mov_b32 s51, 0x20000
    s_mov_b32 s50, 0x400000
    s_mov_b32 s60, s24
    s_mov_b32 s61, s25
    s_mov_b32 s62, 2048
    s_mov_b32 s63, 0x20000
    s_mov_b32 s75, 0x3db504f3
    s_mov_b32 s76, 0x3fb8aa3b
    s_mov_b32 s77, 0xffff0000
    v_lshrrev_b32 v7, 3, v0
    v_lshlrev_b32 v127, 12, v7
    v_and_b32 v7, 7, v0
    v_lshlrev_b32 v7, 4, v7
    v_or_b32 v127, v127, v7
    s_lshl_b32 s83, s65, 4
    s_and_b32 s72, s66, 15
    s_add_u32 s83, s83, s72
    s_lshl_b32 s83, s83, 15
    s_and_b32 s72, s64, 3
    s_lshl_b32 s72, s72, 8
    s_add_u32 s83, s83, s72
    v_lshlrev_b32 v11, 5, v6
    v_lshrrev_b32 v7, 1, v0
    v_and_b32 v7, 24, v7
    v_or_b32 v11, v11, v7
    v_add_u32 v11, s78, v11
    v_mov_b32 v40, 0xffff
    v_mov_b32 v41, s77
    v_mov_b32 v42, 0
    v_cmp_eq_u32 vcc, 0, v6
    s_nop 1
    v_cndmask_b32 v24, v42, v40, vcc
    v_cmp_eq_u32 vcc, 1, v6
    s_nop 1
    v_cndmask_b32 v24, v24, v41, vcc
    v_cmp_eq_u32 vcc, 2, v6
    s_nop 1
    v_cndmask_b32 v25, v42, v40, vcc
    v_cmp_eq_u32 vcc, 3, v6
    s_nop 1
    v_cndmask_b32 v7, v25, v41, vcc
    v_mov_b32 v6, v24
    s_cmp_eq_u32 s64, 7
    s_cbranch_scc1 L_w7c
    s_waitcnt vmcnt(8)
    s_branch L_w7d
L_w7c:
    s_waitcnt vmcnt(0)
L_w7d:
    v_lshlrev_b32 v122, 16, v120
    v_and_b32 v123, s77, v120
    v_lshlrev_b32 v124, 16, v121
    v_and_b32 v125, s77, v121
    v_lshlrev_b32 v48, 16, v104
    v_and_b32 v49, s77, v104
    v_lshlrev_b32 v50, 16, v105
    v_and_b32 v51, s77, v105
    v_lshlrev_b32 v52, 16, v106
    v_and_b32 v53, s77, v106
    v_lshlrev_b32 v54, 16, v107
    v_and_b32 v55, s77, v107
    v_mul_f32 v40, v122, v48
    v_mul_f32 v41, v122, v49
    v_mul_f32 v42, v122, v50
    v_mul_f32 v43, v122, v51
    v_mul_f32 v44, v122, v52
    v_mul_f32 v45, v122, v53
    v_mul_f32 v46, v122, v54
    v_mul_f32 v47, v122, v55
    v_lshlrev_b32 v48, 16, v108
    v_and_b32 v49, s77, v108
    v_lshlrev_b32 v50, 16, v109
    v_and_b32 v51, s77, v109
    v_lshlrev_b32 v52, 16, v110
    v_and_b32 v53, s77, v110
    v_lshlrev_b32 v54, 16, v111
    v_and_b32 v55, s77, v111
    v_fmac_f32 v40, v123, v48
    v_fmac_f32 v41, v123, v49
    v_fmac_f32 v42, v123, v50
    v_fmac_f32 v43, v123, v51
    v_fmac_f32 v44, v123, v52
    v_fmac_f32 v45, v123, v53
    v_fmac_f32 v46, v123, v54
    v_fmac_f32 v47, v123, v55
    v_lshlrev_b32 v48, 16, v112
    v_and_b32 v49, s77, v112
    v_lshlrev_b32 v50, 16, v113
    v_and_b32 v51, s77, v113
    v_lshlrev_b32 v52, 16, v114
    v_and_b32 v53, s77, v114
    v_lshlrev_b32 v54, 16, v115
    v_and_b32 v55, s77, v115
    v_fmac_f32 v40, v124, v48
    v_fmac_f32 v41, v124, v49
    v_fmac_f32 v42, v124, v50
    v_fmac_f32 v43, v124, v51
    v_fmac_f32 v44, v124, v52
    v_fmac_f32 v45, v124, v53
    v_fmac_f32 v46, v124, v54
    v_fmac_f32 v47, v124, v55
    v_lshlrev_b32 v48, 16, v116
    v_and_b32 v49, s77, v116
    v_lshlrev_b32 v50, 16, v117
    v_and_b32 v51, s77, v117
    v_lshlrev_b32 v52, 16, v118
    v_and_b32 v53, s77, v118
    v_lshlrev_b32 v54, 16, v119
    v_and_b32 v55, s77, v119
    v_fmac_f32 v40, v125, v48
    v_fmac_f32 v41, v125, v49
    v_fmac_f32 v42, v125, v50
    v_fmac_f32 v43, v125, v51
    v_fmac_f32 v44, v125, v52
    v_fmac_f32 v45, v125, v53
    v_fmac_f32 v46, v125, v54
    v_fmac_f32 v47, v125, v55
    v_permlane32_swap_b32 v40, v44
    v_permlane32_swap_b32 v41, v45
    v_permlane32_swap_b32 v42, v46
    v_permlane32_swap_b32 v43, v47
    v_add_f32 v40, v40, v44
    v_add_f32 v41, v41, v45
    v_add_f32 v42, v42, v46
    v_add_f32 v43, v43, v47
    s_nop 0
    v_permlane16_swap_b32 v40, v42
    v_permlane16_swap_b32 v41, v43
    v_add_f32 v40, v40, v42
    v_add_f32 v41, v41, v43
    s_nop 0
    v_add_f32_dpp v40, v40, v40 row_ror:4 row_mask:0xf bank_mask:0xf
    v_add_f32_dpp v41, v41, v41 row_ror:4 row_mask:0xf bank_mask:0xf
    s_nop 0
    v_add_f32_dpp v40, v40, v40 row_ror:8 row_mask:0xf bank_mask:0xf
    v_add_f32_dpp v41, v41, v41 row_ror:8 row_mask:0xf bank_mask:0xf
    ds_write_b64 v11, v[40:41] offset:256
    s_cmp_eq_u32 s64, 7
    s_cbranch_scc1 L_w7e
    s_waitcnt lgkmcnt(0)
    s_barrier
    s_cmp_lt_u32 s64, 4
    s_cbranch_scc1 L_nowo
    s_setprio 3
    buffer_load_dwordx4 v[56:59], v127, s[48:51], s83 offen offset:0 nt
    buffer_load_dwordx4 v[60:63], v127, s[48:51], s83 offen offset:1024 nt
    buffer_load_dwordx4 v[64:67], v127, s[48:51], s83 offen offset:2048 nt
    buffer_load_dwordx4 v[68:71], v127, s[48:51], s83 offen offset:3072 nt
    buffer_load_dwordx4 v[72:75], v127, s[48:51], s83 offen offset:128 nt
    buffer_load_dwordx4 v[76:79], v127, s[48:51], s83 offen offset:1152 nt
    buffer_load_dwordx4 v[80:83], v127, s[48:51], s83 offen offset:2176 nt
    buffer_load_dwordx4 v[84:87], v127, s[48:51], s83 offen offset:3200 nt
    s_waitcnt vmcnt(12)
L_nowo:
    s_add_u32 s70, s70, 28672
    buffer_load_dwordx4 v[160:163], v1, s[32:35], s70 offen offset:0 nt
    buffer_load_dwordx4 v[164:167], v1, s[32:35], s70 offen offset:64 nt
    buffer_load_dwordx4 v[168:171], v1, s[32:35], s70 offen offset:128 nt
    buffer_load_dwordx4 v[172:175], v1, s[32:35], s70 offen offset:192 nt
    s_waitcnt vmcnt(8)
    buffer_load_dwordx4 v[176:179], v2, s[36:39], s70 offen offset:0 nt
    buffer_load_dwordx4 v[180:183], v2, s[36:39], s70 offen offset:1024 nt
    buffer_load_dwordx4 v[184:187], v2, s[36:39], s70 offen offset:2048 nt
    buffer_load_dwordx4 v[188:191], v2, s[36:39], s70 offen offset:3072 nt
    s_add_u32 s70, s70, 28672
    s_waitcnt vmcnt(4)
    buffer_load_dwordx4 v[192:195], v1, s[32:35], s70 offen offset:0 nt
    buffer_load_dwordx4 v[196:199], v1, s[32:35], s70 offen offset:64 nt
    buffer_load_dwordx4 v[200:203], v1, s[32:35], s70 offen offset:128 nt
    buffer_load_dwordx4 v[204:207], v1, s[32:35], s70 offen offset:192 nt
    s_waitcnt vmcnt(4)
    buffer_load_dwordx4 v[208:211], v2, s[36:39], s70 offen offset:0 nt
    buffer_load_dwordx4 v[212:215], v2, s[36:39], s70 offen offset:1024 nt
    buffer_load_dwordx4 v[216:219], v2, s[36:39], s70 offen offset:2048 nt
    buffer_load_dwordx4 v[220:223], v2, s[36:39], s70 offen offset:3072 nt
    s_barrier
    s_branch L_main
L_w7e:
    s_setprio 3
    s_waitcnt lgkmcnt(0)
    s_barrier
    v_and_b32 v11, 15, v0
    v_lshlrev_b32 v11, 3, v11
    ds_read_b64 v[24:25], v11 offset:256
    ds_read_b64 v[26:27], v11 offset:384
    ds_read_b64 v[28:29], v11 offset:512
    ds_read_b64 v[30:31], v11 offset:640
    ds_read_b64 v[32:33], v11 offset:768
    ds_read_b64 v[34:35], v11 offset:896
    ds_read_b64 v[36:37], v11 offset:1024
    ds_read_b64 v[38:39], v11 offset:1152
    v_readfirstlane_b32 s73, v126
    s_add_u32 s73, s73, 1
    s_lshr_b32 s72, s66, 4
    s_lshl_b32 s72, s72, 3
    s_add_u32 s72, s72, s65
    s_lshl_b32 s72, s72, 11
    s_lshl_b32 s79, s79, 7
    s_add_u32 s72, s72, s79
    s_add_u32 s72, s72, 4096
    s_cmp_ge_u32 s67, 30
    s_cselect_b32 s71, 8, 0
    s_add_u32 s71, s71, s65
    s_lshl_b32 s71, s71, 11
    s_add_u32 s71, s71, 4096
    v_mov_b32 v41, s73
    ds_write_b32 v3, v41 offset:4
    s_waitcnt lgkmcnt(0)
    v_add_f32 v24, v24, v32
    v_add_f32 v25, v25, v33
    v_add_f32 v26, v26, v34
    v_add_f32 v27, v27, v35
    v_add_f32 v28, v28, v36
    v_add_f32 v29, v29, v37
    v_add_f32 v30, v30, v38
    v_add_f32 v31, v31, v39
    v_add_f32 v24, v24, v28
    v_add_f32 v25, v25, v29
    v_add_f32 v26, v26, v30
    v_add_f32 v27, v27, v31
    v_add_f32 v24, v24, v26
    v_add_f32 v25, v25, v27
    v_cvt_pk_bf16_f32 v40, v24, v25
    s_mov_b64 exec, 0xffff
    buffer_store_dwordx2 v[40:41], v11, s[52:55], s72 offen sc1
    s_mov_b64 exec, -1
    s_mov_b32 s74, 400000
L_qpoll:
    buffer_load_dwordx4 v[24:27], v2, s[52:55], s71 offen sc1
    buffer_load_dwordx4 v[28:31], v2, s[52:55], s71 offen offset:1024 sc1
    s_waitcnt vmcnt(0)
    v_xor_b32 v33, s73, v25
    v_xor_b32 v34, s73, v27
    v_xor_b32 v35, s73, v29
    v_xor_b32 v36, s73, v31
    v_or3_b32 v33, v33, v34, v35
    v_or_b32 v33, v33, v36
    v_cmp_ne_u32 vcc, 0, v33
    s_cbranch_vccz L_qdone
    s_sub_u32 s74, s74, 1
    s_cbranch_scc0 L_qpoll
L_qdone:
    v_mov_b32 v25, v26
    v_mov_b32 v29, v30
    v_lshlrev_b32 v11, 3, v0
    ds_write_b64 v11, v[24:25] offset:2048
    ds_write_b64 v11, v[28:29] offset:2560
    s_waitcnt lgkmcnt(0)
    s_barrier
    buffer_load_dwordx4 v[56:59], v127, s[48:51], s83 offen offset:0 nt
    buffer_load_dwordx4 v[60:63], v127, s[48:51], s83 offen offset:1024 nt
    buffer_load_dwordx4 v[64:67], v127, s[48:51], s83 offen offset:2048 nt
    buffer_load_dwordx4 v[68:71], v127, s[48:51], s83 offen offset:3072 nt
    buffer_load_dwordx4 v[72:75], v127, s[48:51], s83 offen offset:128 nt
    buffer_load_dwordx4 v[76:79], v127, s[48:51], s83 offen offset:1152 nt
    buffer_load_dwordx4 v[80:83], v127, s[48:51], s83 offen offset:2176 nt
    buffer_load_dwordx4 v[84:87], v127, s[48:51], s83 offen offset:3200 nt
L_main:
    v_bfe_u32 v11, v0, 2, 2
    v_lshlrev_b32 v11, 8, v11
    v_and_b32 v3, 48, v0
    v_or_b32 v11, v11, v3
    ds_read_b128 v[24:27], v11 offset:2048
    ds_read_b128 v[28:31], v11 offset:2112
    ds_read_b128 v[32:35], v11 offset:2176
    ds_read_b128 v[36:39], v11 offset:2240
    v_mov_b32 v4, 0
    v_mov_b32 v5, 1
    ds_read_b32 v106, v4 offset:4
    s_cmp_lt_u32 s64, 4
    s_cselect_b64 exec, 1, 0
    ds_add_rtn_u32 v3, v4, v5
    s_mov_b64 exec, -1
    v_mov_b32 v16, 0
    v_mov_b32 v17, 0
    v_mov_b32 v18, 0
    v_mov_b32 v19, 0
    v_mov_b32 v20, 0
    v_mov_b32 v21, 0
    v_mov_b32 v22, 0
    v_mov_b32 v23, 0
    v_mov_b32 v8, 0xff800000
    v_mov_b32 v9, 0xff800000
    v_mov_b32 v10, 0
    v_lshlrev_b32 v104, 5, v0
    s_lshl_b32 s71, s64, 11
    v_add_u32 v104, s71, v104
    v_bfe_u32 v105, v0, 2, 2
    v_lshlrev_b32 v105, 5, v105
    s_lshl_b32 s71, s64, 2
    s_add_u32 s71, s71, 0xc00
    v_add_u32 v105, s71, v105
    s_waitcnt lgkmcnt(1)
    s_cmp_ge_u32 s64, 4
    s_cbranch_scc1 L_help
    s_lshl_b32 s70, s64, 12
    s_add_u32 s70, s70, s68
    s_add_u32 s70, s70, 69632
    s_waitcnt vmcnt(20)
    v_mfma_f32_16x16x32_bf16 v[12:15], v[128:131], v[24:27], 0
    v_mfma_f32_16x16x32_bf16 v[12:15], v[132:135], v[28:31], v[12:15]
    v_mfma_f32_16x16x32_bf16 v[12:15], v[136:139], v[32:35], v[12:15]
    v_mfma_f32_16x16x32_bf16 v[12:15], v[140:143], v[36:39], v[12:15]
    s_add_u32 s70, s70, 16384
    s_waitcnt lgkmcnt(0)
    v_readfirstlane_b32 s72, v3
    s_add_u32 s71, s72, s88
    v_mov_b32 v110, s71
    s_cmp_ge_u32 s72, s89
    s_cselect_b64 exec, 1, 0
    v_mov_b32 v110, 1
    buffer_atomic_add v110, v4, s[52:55], s90 offen sc0 sc1
    s_mov_b64 exec, 1
    ds_add_rtn_u32 v3, v4, v5
    s_mov_b64 exec, -1
    buffer_load_dwordx4 v[128:131], v1, s[32:35], s70 offen offset:0 nt
    buffer_load_dwordx4 v[132:135], v1, s[32:35], s70 offen offset:64 nt
    buffer_load_dwordx4 v[136:139], v1, s[32:35], s70 offen offset:128 nt
    buffer_load_dwordx4 v[140:143], v1, s[32:35], s70 offen offset:192 nt
    v_cvt_pk_bf16_f32 v40, v12, v13
    v_cvt_pk_bf16_f32 v41, v14, v15
    v_lshlrev_b32 v42, 16, v40
    v_and_b32 v43, s77, v40
    v_lshlrev_b32 v44, 16, v41
    v_and_b32 v45, s77, v41
    v_mul_f32 v42, s75, v42
    v_mul_f32 v43, s75, v43
    v_mul_f32 v44, s75, v44
    v_mul_f32 v45, s75, v45
    v_cvt_pk_bf16_f32 v40, v42, v43
    v_cvt_pk_bf16_f32 v41, v44, v45
    v_lshlrev_b32 v42, 16, v40
    v_and_b32 v43, s77, v40
    v_lshlrev_b32 v44, 16, v41
    v_and_b32 v45, s77, v41
    v_max3_f32 v46, v42, v43, v44
    v_max_f32 v46, v46, v45
    v_cmp_gt_f32 vcc, v46, v8
    s_cbranch_vccz L_skip0
    v_max_f32 v46, v46, v8
    v_mov_b32 v47, v46
    s_nop 1
    v_permlane16_swap_b32 v46, v47
    v_max_f32 v46, v46, v47
    v_mov_b32 v47, v46
    s_nop 1
    v_permlane32_swap_b32 v46, v47
    v_max_f32 v8, v46, v47
    v_mul_f32 v47, s76, v8
    v_sub_f32 v46, v9, v47
    v_exp_f32 v46, v46
    v_mov_b32 v9, v47
    v_mul_f32 v10, v10, v46
    v_mov_b32_dpp v47, v46 row_newbcast:0 row_mask:0x1 bank_mask:0xf
    s_nop 1
    v_mov_b32_dpp v47, v46 row_newbcast:4 row_mask:0x2 bank_mask:0xf
    s_nop 1
    v_mov_b32_dpp v47, v46 row_newbcast:8 row_mask:0x4 bank_mask:0xf
    s_nop 1
    v_mov_b32_dpp v47, v46 row_newbcast:12 row_mask:0x8 bank_mask:0xf
    v_mul_f32 v16, v16, v47
    v_mul_f32 v17, v17, v47
    v_mul_f32 v18, v18, v47
    v_mul_f32 v19, v19, v47
    v_mul_f32 v20, v20, v47
    v_mul_f32 v21, v21, v47
    v_mul_f32 v22, v22, v47
    v_mul_f32 v23, v23, v47
L_skip0:
    v_fma_f32 v42, v42, s76, -v9
    v_fma_f32 v43, v43, s76, -v9
    v_fma_f32 v44, v44, s76, -v9
    v_fma_f32 v45, v45, s76, -v9
    v_exp_f32 v42, v42
    v_exp_f32 v43, v43
    v_exp_f32 v44, v44
    v_exp_f32 v45, v45
    v_cvt_pk_bf16_f32 v49, v42, v42
    v_cvt_pk_bf16_f32 v51, v43, v43
    v_cvt_pk_bf16_f32 v53, v44, v44
    v_cvt_pk_bf16_f32 v55, v45, v45
    v_and_b32 v48, v6, v49
    v_and_b32 v49, v7, v49
    v_and_b32 v50, v6, v51
    v_and_b32 v51, v7, v51
    v_and_b32 v52, v6, v53
    v_and_b32 v53, v7, v53
    v_and_b32 v54, v6, v55
    v_and_b32 v55, v7, v55
    v_add_f32 v42, v42, v43
    v_add_f32 v44, v44, v45
    v_add_f32 v10, v10, v42
    v_add_f32 v10, v10, v44
    s_waitcnt vmcnt(21)
    v_mfma_f32_16x16x16_bf16 v[16:19], v[48:49], v[144:145], v[16:19]
    v_mfma_f32_16x16x16_bf16 v[20:23], v[48:49], v[146:147], v[20:23]
    v_mfma_f32_16x16x16_bf16 v[16:19], v[50:51], v[148:149], v[16:19]
    v_mfma_f32_16x16x16_bf16 v[20:23], v[50:51], v[150:151], v[20:23]
    v_mfma_f32_16x16x16_bf16 v[16:19], v[52:53], v[152:153], v[16:19]
    v_mfma_f32_16x16x16_bf16 v[20:23], v[52:53], v[154:155], v[20:23]
    v_mfma_f32_16x16x16_bf16 v[16:19], v[54:55], v[156:157], v[16:19]
    v_mfma_f32_16x16x16_bf16 v[20:23], v[54:55], v[158:159], v[20:23]
    buffer_load_dwordx4 v[144:147], v2, s[36:39], s70 offen offset:0 nt
    buffer_load_dwordx4 v[148:151], v2, s[36:39], s70 offen offset:1024 nt
    buffer_load_dwordx4 v[152:155], v2, s[36:39], s70 offen offset:2048 nt
    buffer_load_dwordx4 v[156:159], v2, s[36:39], s70 offen offset:3072 nt
    s_waitcnt vmcnt(21)
    v_mfma_f32_16x16x32_bf16 v[12:15], v[160:163], v[24:27], 0
    v_mfma_f32_16x16x32_bf16 v[12:15], v[164:167], v[28:31], v[12:15]
    v_mfma_f32_16x16x32_bf16 v[12:15], v[168:171], v[32:35], v[12:15]
    v_mfma_f32_16x16x32_bf16 v[12:15], v[172:175], v[36:39], v[12:15]
    s_add_u32 s70, s70, 16384
    s_waitcnt lgkmcnt(0)
    v_readfirstlane_b32 s72, v3
    s_add_u32 s71, s72, s88
    v_mov_b32 v111, s71
    s_cmp_ge_u32 s72, s89
    s_cselect_b64 exec, 1, 0
    v_mov_b32 v111, 1
    buffer_atomic_add v111, v4, s[52:55], s90 offen sc0 sc1
    s_mov_b64 exec, 1
    ds_add_rtn_u32 v3, v4, v5
    s_mov_b64 exec, -1
    buffer_load_dwordx4 v[160:163], v1, s[32:35], s70 offen offset:0 nt
    buffer_load_dwordx4 v[164:167], v1, s[32:35], s70 offen offset:64 nt
    buffer_load_dwordx4 v[168:171], v1, s[32:35], s70 offen offset:128 nt
    buffer_load_dwordx4 v[172:175], v1, s[32:35], s70 offen offset:192 nt
    v_cvt_pk_bf16_f32 v40, v12, v13
    v_cvt_pk_bf16_f32 v41, v14, v15
    v_lshlrev_b32 v42, 16, v40
    v_and_b32 v43, s77, v40
    v_lshlrev_b32 v44, 16, v41
    v_and_b32 v45, s77, v41
    v_mul_f32 v42, s75, v42
    v_mul_f32 v43, s75, v43
    v_mul_f32 v44, s75, v44
    v_mul_f32 v45, s75, v45
    v_cvt_pk_bf16_f32 v40, v42, v43
    v_cvt_pk_bf16_f32 v41, v44, v45
    v_lshlrev_b32 v42, 16, v40
    v_and_b32 v43, s77, v40
    v_lshlrev_b32 v44, 16, v41
    v_and_b32 v45, s77, v41
    v_max3_f32 v46, v42, v43, v44
    v_max_f32 v46, v46, v45
    v_cmp_gt_f32 vcc, v46, v8
    s_cbranch_vccz L_skip1
    v_max_f32 v46, v46, v8
    v_mov_b32 v47, v46
    s_nop 1
    v_permlane16_swap_b32 v46, v47
    v_max_f32 v46, v46, v47
    v_mov_b32 v47, v46
    s_nop 1
    v_permlane32_swap_b32 v46, v47
    v_max_f32 v8, v46, v47
    v_mul_f32 v47, s76, v8
    v_sub_f32 v46, v9, v47
    v_exp_f32 v46, v46
    v_mov_b32 v9, v47
    v_mul_f32 v10, v10, v46
    v_mov_b32_dpp v47, v46 row_newbcast:0 row_mask:0x1 bank_mask:0xf
    s_nop 1
    v_mov_b32_dpp v47, v46 row_newbcast:4 row_mask:0x2 bank_mask:0xf
    s_nop 1
    v_mov_b32_dpp v47, v46 row_newbcast:8 row_mask:0x4 bank_mask:0xf
    s_nop 1
    v_mov_b32_dpp v47, v46 row_newbcast:12 row_mask:0x8 bank_mask:0xf
    v_mul_f32 v16, v16, v47
    v_mul_f32 v17, v17, v47
    v_mul_f32 v18, v18, v47
    v_mul_f32 v19, v19, v47
    v_mul_f32 v20, v20, v47
    v_mul_f32 v21, v21, v47
    v_mul_f32 v22, v22, v47
    v_mul_f32 v23, v23, v47
L_skip1:
    v_fma_f32 v42, v42, s76, -v9
    v_fma_f32 v43, v43, s76, -v9
    v_fma_f32 v44, v44, s76, -v9
    v_fma_f32 v45, v45, s76, -v9
    v_exp_f32 v42, v42
    v_exp_f32 v43, v43
    v_exp_f32 v44, v44
    v_exp_f32 v45, v45
    v_cvt_pk_bf16_f32 v49, v42, v42
    v_cvt_pk_bf16_f32 v51, v43, v43
    v_cvt_pk_bf16_f32 v53, v44, v44
    v_cvt_pk_bf16_f32 v55, v45, v45
    v_and_b32 v48, v6, v49
    v_and_b32 v49, v7, v49
    v_and_b32 v50, v6, v51
    v_and_b32 v51, v7, v51
    v_and_b32 v52, v6, v53
    v_and_b32 v53, v7, v53
    v_and_b32 v54, v6, v55
    v_and_b32 v55, v7, v55
    v_add_f32 v42, v42, v43
    v_add_f32 v44, v44, v45
    v_add_f32 v10, v10, v42
    v_add_f32 v10, v10, v44
    s_waitcnt vmcnt(22)
    v_mfma_f32_16x16x16_bf16 v[16:19], v[48:49], v[176:177], v[16:19]
    v_mfma_f32_16x16x16_bf16 v[20:23], v[48:49], v[178:179], v[20:23]
    v_mfma_f32_16x16x16_bf16 v[16:19], v[50:51], v[180:181], v[16:19]
    v_mfma_f32_16x16x16_bf16 v[20:23], v[50:51], v[182:183], v[20:23]
    v_mfma_f32_16x16x16_bf16 v[16:19], v[52:53], v[184:185], v[16:19]
    v_mfma_f32_16x16x16_bf16 v[20:23], v[52:53], v[186:187], v[20:23]
    v_mfma_f32_16x16x16_bf16 v[16:19], v[54:55], v[188:189], v[16:19]
    v_mfma_f32_16x16x16_bf16 v[20:23], v[54:55], v[190:191], v[20:23]
    buffer_load_dwordx4 v[176:179], v2, s[36:39], s70 offen offset:0 nt
    buffer_load_dwordx4 v[180:183], v2, s[36:39], s70 offen offset:1024 nt
    buffer_load_dwordx4 v[184:187], v2, s[36:39], s70 offen offset:2048 nt
    buffer_load_dwordx4 v[188:191], v2, s[36:39], s70 offen offset:3072 nt
    s_waitcnt vmcnt(22)
    v_mfma_f32_16x16x32_bf16 v[12:15], v[192:195], v[24:27], 0
    v_mfma_f32_16x16x32_bf16 v[12:15], v[196:199], v[28:31], v[12:15]
    v_mfma_f32_16x16x32_bf16 v[12:15], v[200:203], v[32:35], v[12:15]
    v_mfma_f32_16x16x32_bf16 v[12:15], v[204:207], v[36:39], v[12:15]
    s_nop 7
    v_cvt_pk_bf16_f32 v40, v12, v13
    v_cvt_pk_bf16_f32 v41, v14, v15
    v_lshlrev_b32 v42, 16, v40
    v_and_b32 v43, s77, v40
    v_lshlrev_b32 v44, 16, v41
    v_and_b32 v45, s77, v41
    v_mul_f32 v42, s75, v42
    v_mul_f32 v43, s75, v43
    v_mul_f32 v44, s75, v44
    v_mul_f32 v45, s75, v45
    v_cvt_pk_bf16_f32 v40, v42, v43
    v_cvt_pk_bf16_f32 v41, v44, v45
    v_lshlrev_b32 v42, 16, v40
    v_and_b32 v43, s77, v40
    v_lshlrev_b32 v44, 16, v41
    v_and_b32 v45, s77, v41
    v_max3_f32 v46, v42, v43, v44
    v_max_f32 v46, v46, v45
    v_cmp_gt_f32 vcc, v46, v8
    s_cbranch_vccz L_skip2
    v_max_f32 v46, v46, v8
    v_mov_b32 v47, v46
    s_nop 1
    v_permlane16_swap_b32 v46, v47
    v_max_f32 v46, v46, v47
    v_mov_b32 v47, v46
    s_nop 1
    v_permlane32_swap_b32 v46, v47
    v_max_f32 v8, v46, v47
    v_mul_f32 v47, s76, v8
    v_sub_f32 v46, v9, v47
    v_exp_f32 v46, v46
    v_mov_b32 v9, v47
    v_mul_f32 v10, v10, v46
    v_mov_b32_dpp v47, v46 row_newbcast:0 row_mask:0x1 bank_mask:0xf
    s_nop 1
    v_mov_b32_dpp v47, v46 row_newbcast:4 row_mask:0x2 bank_mask:0xf
    s_nop 1
    v_mov_b32_dpp v47, v46 row_newbcast:8 row_mask:0x4 bank_mask:0xf
    s_nop 1
    v_mov_b32_dpp v47, v46 row_newbcast:12 row_mask:0x8 bank_mask:0xf
    v_mul_f32 v16, v16, v47
    v_mul_f32 v17, v17, v47
    v_mul_f32 v18, v18, v47
    v_mul_f32 v19, v19, v47
    v_mul_f32 v20, v20, v47
    v_mul_f32 v21, v21, v47
    v_mul_f32 v22, v22, v47
    v_mul_f32 v23, v23, v47
L_skip2:
    v_fma_f32 v42, v42, s76, -v9
    v_fma_f32 v43, v43, s76, -v9
    v_fma_f32 v44, v44, s76, -v9
    v_fma_f32 v45, v45, s76, -v9
    v_exp_f32 v42, v42
    v_exp_f32 v43, v43
    v_exp_f32 v44, v44
    v_exp_f32 v45, v45
    v_cvt_pk_bf16_f32 v49, v42, v42
    v_cvt_pk_bf16_f32 v51, v43, v43
    v_cvt_pk_bf16_f32 v53, v44, v44
    v_cvt_pk_bf16_f32 v55, v45, v45
    v_and_b32 v48, v6, v49
    v_and_b32 v49, v7, v49
    v_and_b32 v50, v6, v51
    v_and_b32 v51, v7, v51
    v_and_b32 v52, v6, v53
    v_and_b32 v53, v7, v53
    v_and_b32 v54, v6, v55
    v_and_b32 v55, v7, v55
    v_add_f32 v42, v42, v43
    v_add_f32 v44, v44, v45
    v_add_f32 v10, v10, v42
    v_add_f32 v10, v10, v44
    s_waitcnt vmcnt(18)
    v_mfma_f32_16x16x16_bf16 v[16:19], v[48:49], v[208:209], v[16:19]
    v_mfma_f32_16x16x16_bf16 v[20:23], v[48:49], v[210:211], v[20:23]
    v_mfma_f32_16x16x16_bf16 v[16:19], v[50:51], v[212:213], v[16:19]
    v_mfma_f32_16x16x16_bf16 v[20:23], v[50:51], v[214:215], v[20:23]
    v_mfma_f32_16x16x16_bf16 v[16:19], v[52:53], v[216:217], v[16:19]
    v_mfma_f32_16x16x16_bf16 v[20:23], v[52:53], v[218:219], v[20:23]
    v_mfma_f32_16x16x16_bf16 v[16:19], v[54:55], v[220:221], v[16:19]
    v_mfma_f32_16x16x16_bf16 v[20:23], v[54:55], v[222:223], v[20:23]
    s_setprio 1
L_loop:
    s_waitcnt vmcnt(13)
    v_mfma_f32_16x16x32_bf16 v[12:15], v[128:131], v[24:27], 0
    v_mfma_f32_16x16x32_bf16 v[12:15], v[132:135], v[28:31], v[12:15]
    v_mfma_f32_16x16x32_bf16 v[12:15], v[136:139], v[32:35], v[12:15]
    v_mfma_f32_16x16x32_bf16 v[12:15], v[140:143], v[36:39], v[12:15]
    v_readfirstlane_b32 s71, v110
    s_lshl_b32 s70, s71, 12
    s_cmp_ge_u32 s70, s69
    s_cbranch_scc1 L_tail0
    s_waitcnt lgkmcnt(0)
    v_readfirstlane_b32 s72, v3
    s_add_u32 s71, s72, s88
    v_mov_b32 v110, s71
    s_cmp_ge_u32 s72, s89
    s_cselect_b64 exec, 1, 0
    v_mov_b32 v110, 1
    buffer_atomic_add v110, v4, s[52:55], s90 offen sc0 sc1
    s_mov_b64 exec, 1
    ds_add_rtn_u32 v3, v4, v5
    s_mov_b64 exec, -1
    buffer_load_dwordx4 v[128:131], v1, s[32:35], s70 offen offset:0 nt
    buffer_load_dwordx4 v[132:135], v1, s[32:35], s70 offen offset:64 nt
    buffer_load_dwordx4 v[136:139], v1, s[32:35], s70 offen offset:128 nt
    buffer_load_dwordx4 v[140:143], v1, s[32:35], s70 offen offset:192 nt
    v_cvt_pk_bf16_f32 v40, v12, v13
    v_cvt_pk_bf16_f32 v41, v14, v15
    v_lshlrev_b32 v42, 16, v40
    v_and_b32 v43, s77, v40
    v_lshlrev_b32 v44, 16, v41
    v_and_b32 v45, s77, v41
    v_mul_f32 v42, s75, v42
    v_mul_f32 v43, s75, v43
    v_mul_f32 v44, s75, v44
    v_mul_f32 v45, s75, v45
    v_cvt_pk_bf16_f32 v40, v42, v43
    v_cvt_pk_bf16_f32 v41, v44, v45
    v_lshlrev_b32 v42, 16, v40
    v_and_b32 v43, s77, v40
    v_lshlrev_b32 v44, 16, v41
    v_and_b32 v45, s77, v41
    v_max3_f32 v46, v42, v43, v44
    v_max_f32 v46, v46, v45
    v_cmp_gt_f32 vcc, v46, v8
    s_cbranch_vccz L_skip3
    v_max_f32 v46, v46, v8
    v_mov_b32 v47, v46
    s_nop 1
    v_permlane16_swap_b32 v46, v47
    v_max_f32 v46, v46, v47
    v_mov_b32 v47, v46
    s_nop 1
    v_permlane32_swap_b32 v46, v47
    v_max_f32 v8, v46, v47
    v_mul_f32 v47, s76, v8
    v_sub_f32 v46, v9, v47
    v_exp_f32 v46, v46
    v_mov_b32 v9, v47
    v_mul_f32 v10, v10, v46
    v_mov_b32_dpp v47, v46 row_newbcast:0 row_mask:0x1 bank_mask:0xf
    s_nop 1
    v_mov_b32_dpp v47, v46 row_newbcast:4 row_mask:0x2 bank_mask:0xf
    s_nop 1
    v_mov_b32_dpp v47, v46 row_newbcast:8 row_mask:0x4 bank_mask:0xf
    s_nop 1
    v_mov_b32_dpp v47, v46 row_newbcast:12 row_mask:0x8 bank_mask:0xf
    v_mul_f32 v16, v16, v47
    v_mul_f32 v17, v17, v47
    v_mul_f32 v18, v18, v47
    v_mul_f32 v19, v19, v47
    v_mul_f32 v20, v20, v47
    v_mul_f32 v21, v21, v47
    v_mul_f32 v22, v22, v47
    v_mul_f32 v23, v23, v47
L_skip3:
    v_fma_f32 v42, v42, s76, -v9
    v_fma_f32 v43, v43, s76, -v9
    v_fma_f32 v44, v44, s76, -v9
    v_fma_f32 v45, v45, s76, -v9
    v_exp_f32 v42, v42
    v_exp_f32 v43, v43
    v_exp_f32 v44, v44
    v_exp_f32 v45, v45
    v_cvt_pk_bf16_f32 v49, v42, v42
    v_cvt_pk_bf16_f32 v51, v43, v43
    v_cvt_pk_bf16_f32 v53, v44, v44
    v_cvt_pk_bf16_f32 v55, v45, v45
    v_and_b32 v48, v6, v49
    v_and_b32 v49, v7, v49
    v_and_b32 v50, v6, v51
    v_and_b32 v51, v7, v51
    v_and_b32 v52, v6, v53
    v_and_b32 v53, v7, v53
    v_and_b32 v54, v6, v55
    v_and_b32 v55, v7, v55
    v_add_f32 v42, v42, v43
    v_add_f32 v44, v44, v45
    v_add_f32 v10, v10, v42
    v_add_f32 v10, v10, v44
    s_waitcnt vmcnt(14)
    v_mfma_f32_16x16x16_bf16 v[16:19], v[48:49], v[144:145], v[16:19]
    v_mfma_f32_16x16x16_bf16 v[20:23], v[48:49], v[146:147], v[20:23]
    v_mfma_f32_16x16x16_bf16 v[16:19], v[50:51], v[148:149], v[16:19]
    v_mfma_f32_16x16x16_bf16 v[20:23], v[50:51], v[150:151], v[20:23]
    v_mfma_f32_16x16x16_bf16 v[16:19], v[52:53], v[152:153], v[16:19]
    v_mfma_f32_16x16x16_bf16 v[20:23], v[52:53], v[154:155], v[20:23]
    v_mfma_f32_16x16x16_bf16 v[16:19], v[54:55], v[156:157], v[16:19]
    v_mfma_f32_16x16x16_bf16 v[20:23], v[54:55], v[158:159], v[20:23]
    buffer_load_dwordx4 v[144:147], v2, s[36:39], s70 offen offset:0 nt
    buffer_load_dwordx4 v[148:151], v2, s[36:39], s70 offen offset:1024 nt
    buffer_load_dwordx4 v[152:155], v2, s[36:39], s70 offen offset:2048 nt
    buffer_load_dwordx4 v[156:159], v2, s[36:39], s70 offen offset:3072 nt
    s_waitcnt vmcnt(13)
    v_mfma_f32_16x16x32_bf16 v[12:15], v[160:163], v[24:27], 0
    v_mfma_f32_16x16x32_bf16 v[12:15], v[164:167], v[28:31], v[12:15]
    v_mfma_f32_16x16x32_bf16 v[12:15], v[168:171], v[32:35], v[12:15]
    v_mfma_f32_16x16x32_bf16 v[12:15], v[172:175], v[36:39], v[12:15]
    v_readfirstlane_b32 s71, v111
    s_lshl_b32 s70, s71, 12
    s_cmp_ge_u32 s70, s69
    s_cbranch_scc1 L_tail1
    s_waitcnt lgkmcnt(0)
    v_readfirstlane_b32 s72, v3
    s_add_u32 s71, s72, s88
    v_mov_b32 v111, s71
    s_cmp_ge_u32 s72, s89
    s_cselect_b64 exec, 1, 0
    v_mov_b32 v111, 1
    buffer_atomic_add v111, v4, s[52:55], s90 offen sc0 sc1
    s_mov_b64 exec, 1
    ds_add_rtn_u32 v3, v4, v5
    s_mov_b64 exec, -1
    buffer_load_dwordx4 v[160:163], v1, s[32:35], s70 offen offset:0 nt
    buffer_load_dwordx4 v[164:167], v1, s[32:35], s70 offen offset:64 nt
    buffer_load_dwordx4 v[168:171], v1, s[32:35], s70 offen offset:128 nt
    buffer_load_dwordx4 v[172:175], v1, s[32:35], s70 offen offset:192 nt
    v_cvt_pk_bf16_f32 v40, v12, v13
    v_cvt_pk_bf16_f32 v41, v14, v15
    v_lshlrev_b32 v42, 16, v40
    v_and_b32 v43, s77, v40
    v_lshlrev_b32 v44, 16, v41
    v_and_b32 v45, s77, v41
    v_mul_f32 v42, s75, v42
    v_mul_f32 v43, s75, v43
    v_mul_f32 v44, s75, v44
    v_mul_f32 v45, s75, v45
    v_cvt_pk_bf16_f32 v40, v42, v43
    v_cvt_pk_bf16_f32 v41, v44, v45
    v_lshlrev_b32 v42, 16, v40
    v_and_b32 v43, s77, v40
    v_lshlrev_b32 v44, 16, v41
    v_and_b32 v45, s77, v41
    v_max3_f32 v46, v42, v43, v44
    v_max_f32 v46, v46, v45
    v_cmp_gt_f32 vcc, v46, v8
    s_cbranch_vccz L_skip4
    v_max_f32 v46, v46, v8
    v_mov_b32 v47, v46
    s_nop 1
    v_permlane16_swap_b32 v46, v47
    v_max_f32 v46, v46, v47
    v_mov_b32 v47, v46
    s_nop 1
    v_permlane32_swap_b32 v46, v47
    v_max_f32 v8, v46, v47
    v_mul_f32 v47, s76, v8
    v_sub_f32 v46, v9, v47
    v_exp_f32 v46, v46
    v_mov_b32 v9, v47
    v_mul_f32 v10, v10, v46
    v_mov_b32_dpp v47, v46 row_newbcast:0 row_mask:0x1 bank_mask:0xf
    s_nop 1
    v_mov_b32_dpp v47, v46 row_newbcast:4 row_mask:0x2 bank_mask:0xf
    s_nop 1
    v_mov_b32_dpp v47, v46 row_newbcast:8 row_mask:0x4 bank_mask:0xf
    s_nop 1
    v_mov_b32_dpp v47, v46 row_newbcast:12 row_mask:0x8 bank_mask:0xf
    v_mul_f32 v16, v16, v47
    v_mul_f32 v17, v17, v47
    v_mul_f32 v18, v18, v47
    v_mul_f32 v19, v19, v47
    v_mul_f32 v20, v20, v47
    v_mul_f32 v21, v21, v47
    v_mul_f32 v22, v22, v47
    v_mul_f32 v23, v23, v47
L_skip4:
    v_fma_f32 v42, v42, s76, -v9
    v_fma_f32 v43, v43, s76, -v9
    v_fma_f32 v44, v44, s76, -v9
    v_fma_f32 v45, v45, s76, -v9
    v_exp_f32 v42, v42
    v_exp_f32 v43, v43
    v_exp_f32 v44, v44
    v_exp_f32 v45, v45
    v_cvt_pk_bf16_f32 v49, v42, v42
    v_cvt_pk_bf16_f32 v51, v43, v43
    v_cvt_pk_bf16_f32 v53, v44, v44
    v_cvt_pk_bf16_f32 v55, v45, v45
    v_and_b32 v48, v6, v49
    v_and_b32 v49, v7, v49
    v_and_b32 v50, v6, v51
    v_and_b32 v51, v7, v51
    v_and_b32 v52, v6, v53
    v_and_b32 v53, v7, v53
    v_and_b32 v54, v6, v55
    v_and_b32 v55, v7, v55
    v_add_f32 v42, v42, v43
    v_add_f32 v44, v44, v45
    v_add_f32 v10, v10, v42
    v_add_f32 v10, v10, v44
    s_waitcnt vmcnt(14)
    v_mfma_f32_16x16x16_bf16 v[16:19], v[48:49], v[176:177], v[16:19]
    v_mfma_f32_16x16x16_bf16 v[20:23], v[48:49], v[178:179], v[20:23]
    v_mfma_f32_16x16x16_bf16 v[16:19], v[50:51], v[180:181], v[16:19]
    v_mfma_f32_16x16x16_bf16 v[20:23], v[50:51], v[182:183], v[20:23]
    v_mfma_f32_16x16x16_bf16 v[16:19], v[52:53], v[184:185], v[16:19]
    v_mfma_f32_16x16x16_bf16 v[20:23], v[52:53], v[186:187], v[20:23]
    v_mfma_f32_16x16x16_bf16 v[16:19], v[54:55], v[188:189], v[16:19]
    v_mfma_f32_16x16x16_bf16 v[20:23], v[54:55], v[190:191], v[20:23]
    buffer_load_dwordx4 v[176:179], v2, s[36:39], s70 offen offset:0 nt
    buffer_load_dwordx4 v[180:183], v2, s[36:39], s70 offen offset:1024 nt
    buffer_load_dwordx4 v[184:187], v2, s[36:39], s70 offen offset:2048 nt
    buffer_load_dwordx4 v[188:191], v2, s[36:39], s70 offen offset:3072 nt
    s_branch L_loop
L_tail0:
    s_barrier
    s_nop 2
    v_cvt_pk_bf16_f32 v40, v12, v13
    v_cvt_pk_bf16_f32 v41, v14, v15
    v_lshlrev_b32 v42, 16, v40
    v_and_b32 v43, s77, v40
    v_lshlrev_b32 v44, 16, v41
    v_and_b32 v45, s77, v41
    v_mul_f32 v42, s75, v42
    v_mul_f32 v43, s75, v43
    v_mul_f32 v44, s75, v44
    v_mul_f32 v45, s75, v45
    v_cvt_pk_bf16_f32 v40, v42, v43
    v_cvt_pk_bf16_f32 v41, v44, v45
    v_lshlrev_b32 v42, 16, v40
    v_and_b32 v43, s77, v40
    v_lshlrev_b32 v44, 16, v41
    v_and_b32 v45, s77, v41
    v_max3_f32 v46, v42, v43, v44
    v_max_f32 v46, v46, v45
    v_cmp_gt_f32 vcc, v46, v8
    s_cbranch_vccz L_skip5
    v_max_f32 v46, v46, v8
    v_mov_b32 v47, v46
    s_nop 1
    v_permlane16_swap_b32 v46, v47
    v_max_f32 v46, v46, v47
    v_mov_b32 v47, v46
    s_nop 1
    v_permlane32_swap_b32 v46, v47
    v_max_f32 v8, v46, v47
    v_mul_f32 v47, s76, v8
    v_sub_f32 v46, v9, v47
    v_exp_f32 v46, v46
    v_mov_b32 v9, v47
    v_mul_f32 v10, v10, v46
    v_mov_b32_dpp v47, v46 row_newbcast:0 row_mask:0x1 bank_mask:0xf
    s_nop 1
    v_mov_b32_dpp v47, v46 row_newbcast:4 row_mask:0x2 bank_mask:0xf
    s_nop 1
    v_mov_b32_dpp v47, v46 row_newbcast:8 row_mask:0x4 bank_mask:0xf
    s_nop 1
    v_mov_b32_dpp v47, v46 row_newbcast:12 row_mask:0x8 bank_mask:0xf
    v_mul_f32 v16, v16, v47
    v_mul_f32 v17, v17, v47
    v_mul_f32 v18, v18, v47
    v_mul_f32 v19, v19, v47
    v_mul_f32 v20, v20, v47
    v_mul_f32 v21, v21, v47
    v_mul_f32 v22, v22, v47
    v_mul_f32 v23, v23, v47
L_skip5:
    v_fma_f32 v42, v42, s76, -v9
    v_fma_f32 v43, v43, s76, -v9
    v_fma_f32 v44, v44, s76, -v9
    v_fma_f32 v45, v45, s76, -v9
    v_exp_f32 v42, v42
    v_exp_f32 v43, v43
    v_exp_f32 v44, v44
    v_exp_f32 v45, v45
    v_cvt_pk_bf16_f32 v49, v42, v42
    v_cvt_pk_bf16_f32 v51, v43, v43
    v_cvt_pk_bf16_f32 v53, v44, v44
    v_cvt_pk_bf16_f32 v55, v45, v45
    v_and_b32 v48, v6, v49
    v_and_b32 v49, v7, v49
    v_and_b32 v50, v6, v51
    v_and_b32 v51, v7, v51
    v_and_b32 v52, v6, v53
    v_and_b32 v53, v7, v53
    v_and_b32 v54, v6, v55
    v_and_b32 v55, v7, v55
    v_add_f32 v42, v42, v43
    v_add_f32 v44, v44, v45
    v_add_f32 v10, v10, v42
    v_add_f32 v10, v10, v44
    s_waitcnt vmcnt(9)
    v_mfma_f32_16x16x16_bf16 v[16:19], v[48:49], v[144:145], v[16:19]
    v_mfma_f32_16x16x16_bf16 v[20:23], v[48:49], v[146:147], v[20:23]
    v_mfma_f32_16x16x16_bf16 v[16:19], v[50:51], v[148:149], v[16:19]
    v_mfma_f32_16x16x16_bf16 v[20:23], v[50:51], v[150:151], v[20:23]
    v_mfma_f32_16x16x16_bf16 v[16:19], v[52:53], v[152:153], v[16:19]
    v_mfma_f32_16x16x16_bf16 v[20:23], v[52:53], v[154:155], v[20:23]
    v_mfma_f32_16x16x16_bf16 v[16:19], v[54:55], v[156:157], v[16:19]
    v_mfma_f32_16x16x16_bf16 v[20:23], v[54:55], v[158:159], v[20:23]
    s_waitcnt vmcnt(4)
    v_mfma_f32_16x16x32_bf16 v[12:15], v[160:163], v[24:27], 0
    v_mfma_f32_16x16x32_bf16 v[12:15], v[164:167], v[28:31], v[12:15]
    v_mfma_f32_16x16x32_bf16 v[12:15], v[168:171], v[32:35], v[12:15]
    v_mfma_f32_16x16x32_bf16 v[12:15], v[172:175], v[36:39], v[12:15]
    s_nop 7
    v_cvt_pk_bf16_f32 v40, v12, v13
    v_cvt_pk_bf16_f32 v41, v14, v15
    v_lshlrev_b32 v42, 16, v40
    v_and_b32 v43, s77, v40
    v_lshlrev_b32 v44, 16, v41
    v_and_b32 v45, s77, v41
    v_mul_f32 v42, s75, v42
    v_mul_f32 v43, s75, v43
    v_mul_f32 v44, s75, v44
    v_mul_f32 v45, s75, v45
    v_cvt_pk_bf16_f32 v40, v42, v43
    v_cvt_pk_bf16_f32 v41, v44, v45
    v_lshlrev_b32 v42, 16, v40
    v_and_b32 v43, s77, v40
    v_lshlrev_b32 v44, 16, v41
    v_and_b32 v45, s77, v41
    v_max3_f32 v46, v42, v43, v44
    v_max_f32 v46, v46, v45
    v_cmp_gt_f32 vcc, v46, v8
    s_cbranch_vccz L_skip6
    v_max_f32 v46, v46, v8
    v_mov_b32 v47, v46
    s_nop 1
    v_permlane16_swap_b32 v46, v47
    v_max_f32 v46, v46, v47
    v_mov_b32 v47, v46
    s_nop 1
    v_permlane32_swap_b32 v46, v47
    v_max_f32 v8, v46, v47
    v_mul_f32 v47, s76, v8
    v_sub_f32 v46, v9, v47
    v_exp_f32 v46, v46
    v_mov_b32 v9, v47
    v_mul_f32 v10, v10, v46
    v_mov_b32_dpp v47, v46 row_newbcast:0 row_mask:0x1 bank_mask:0xf
    s_nop 1
    v_mov_b32_dpp v47, v46 row_newbcast:4 row_mask:0x2 bank_mask:0xf
    s_nop 1
    v_mov_b32_dpp v47, v46 row_newbcast:8 row_mask:0x4 bank_mask:0xf
    s_nop 1
    v_mov_b32_dpp v47, v46 row_newbcast:12 row_mask:0x8 bank_mask:0xf
    v_mul_f32 v16, v16, v47
    v_mul_f32 v17, v17, v47
    v_mul_f32 v18, v18, v47
    v_mul_f32 v19, v19, v47
    v_mul_f32 v20, v20, v47
    v_mul_f32 v21, v21, v47
    v_mul_f32 v22, v22, v47
    v_mul_f32 v23, v23, v47
L_skip6:
    v_fma_f32 v42, v42, s76, -v9
    v_fma_f32 v43, v43, s76, -v9
    v_fma_f32 v44, v44, s76, -v9
    v_fma_f32 v45, v45, s76, -v9
    v_exp_f32 v42, v42
    v_exp_f32 v43, v43
    v_exp_f32 v44, v44
    v_exp_f32 v45, v45
    v_cvt_pk_bf16_f32 v49, v42, v42
    v_cvt_pk_bf16_f32 v51, v43, v43
    v_cvt_pk_bf16_f32 v53, v44, v44
    v_cvt_pk_bf16_f32 v55, v45, v45
    v_and_b32 v48, v6, v49
    v_and_b32 v49, v7, v49
    v_and_b32 v50, v6, v51
    v_and_b32 v51, v7, v51
    v_and_b32 v52, v6, v53
    v_and_b32 v53, v7, v53
    v_and_b32 v54, v6, v55
    v_and_b32 v55, v7, v55
    v_add_f32 v42, v42, v43
    v_add_f32 v44, v44, v45
    v_add_f32 v10, v10, v42
    v_add_f32 v10, v10, v44
    s_waitcnt vmcnt(0)
    v_mfma_f32_16x16x16_bf16 v[16:19], v[48:49], v[176:177], v[16:19]
    v_mfma_f32_16x16x16_bf16 v[20:23], v[48:49], v[178:179], v[20:23]
    v_mfma_f32_16x16x16_bf16 v[16:19], v[50:51], v[180:181], v[16:19]
    v_mfma_f32_16x16x16_bf16 v[20:23], v[50:51], v[182:183], v[20:23]
    v_mfma_f32_16x16x16_bf16 v[16:19], v[52:53], v[184:185], v[16:19]
    v_mfma_f32_16x16x16_bf16 v[20:23], v[52:53], v[186:187], v[20:23]
    v_mfma_f32_16x16x16_bf16 v[16:19], v[54:55], v[188:189], v[16:19]
    v_mfma_f32_16x16x16_bf16 v[20:23], v[54:55], v[190:191], v[20:23]
    s_branch L_epi0
L_tail1:
    s_barrier
    s_nop 2
    v_cvt_pk_bf16_f32 v40, v12, v13
    v_cvt_pk_bf16_f32 v41, v14, v15
    v_lshlrev_b32 v42, 16, v40
    v_and_b32 v43, s77, v40
    v_lshlrev_b32 v44, 16, v41
    v_and_b32 v45, s77, v41
    v_mul_f32 v42, s75, v42
    v_mul_f32 v43, s75, v43
    v_mul_f32 v44, s75, v44
    v_mul_f32 v45, s75, v45
    v_cvt_pk_bf16_f32 v40, v42, v43
    v_cvt_pk_bf16_f32 v41, v44, v45
    v_lshlrev_b32 v42, 16, v40
    v_and_b32 v43, s77, v40
    v_lshlrev_b32 v44, 16, v41
    v_and_b32 v45, s77, v41
    v_max3_f32 v46, v42, v43, v44
    v_max_f32 v46, v46, v45
    v_cmp_gt_f32 vcc, v46, v8
    s_cbranch_vccz L_skip7
    v_max_f32 v46, v46, v8
    v_mov_b32 v47, v46
    s_nop 1
    v_permlane16_swap_b32 v46, v47
    v_max_f32 v46, v46, v47
    v_mov_b32 v47, v46
    s_nop 1
    v_permlane32_swap_b32 v46, v47
    v_max_f32 v8, v46, v47
    v_mul_f32 v47, s76, v8
    v_sub_f32 v46, v9, v47
    v_exp_f32 v46, v46
    v_mov_b32 v9, v47
    v_mul_f32 v10, v10, v46
    v_mov_b32_dpp v47, v46 row_newbcast:0 row_mask:0x1 bank_mask:0xf
    s_nop 1
    v_mov_b32_dpp v47, v46 row_newbcast:4 row_mask:0x2 bank_mask:0xf
    s_nop 1
    v_mov_b32_dpp v47, v46 row_newbcast:8 row_mask:0x4 bank_mask:0xf
    s_nop 1
    v_mov_b32_dpp v47, v46 row_newbcast:12 row_mask:0x8 bank_mask:0xf
    v_mul_f32 v16, v16, v47
    v_mul_f32 v17, v17, v47
    v_mul_f32 v18, v18, v47
    v_mul_f32 v19, v19, v47
    v_mul_f32 v20, v20, v47
    v_mul_f32 v21, v21, v47
    v_mul_f32 v22, v22, v47
    v_mul_f32 v23, v23, v47
L_skip7:
    v_fma_f32 v42, v42, s76, -v9
    v_fma_f32 v43, v43, s76, -v9
    v_fma_f32 v44, v44, s76, -v9
    v_fma_f32 v45, v45, s76, -v9
    v_exp_f32 v42, v42
    v_exp_f32 v43, v43
    v_exp_f32 v44, v44
    v_exp_f32 v45, v45
    v_cvt_pk_bf16_f32 v49, v42, v42
    v_cvt_pk_bf16_f32 v51, v43, v43
    v_cvt_pk_bf16_f32 v53, v44, v44
    v_cvt_pk_bf16_f32 v55, v45, v45
    v_and_b32 v48, v6, v49
    v_and_b32 v49, v7, v49
    v_and_b32 v50, v6, v51
    v_and_b32 v51, v7, v51
    v_and_b32 v52, v6, v53
    v_and_b32 v53, v7, v53
    v_and_b32 v54, v6, v55
    v_and_b32 v55, v7, v55
    v_add_f32 v42, v42, v43
    v_add_f32 v44, v44, v45
    v_add_f32 v10, v10, v42
    v_add_f32 v10, v10, v44
    s_waitcnt vmcnt(9)
    v_mfma_f32_16x16x16_bf16 v[16:19], v[48:49], v[176:177], v[16:19]
    v_mfma_f32_16x16x16_bf16 v[20:23], v[48:49], v[178:179], v[20:23]
    v_mfma_f32_16x16x16_bf16 v[16:19], v[50:51], v[180:181], v[16:19]
    v_mfma_f32_16x16x16_bf16 v[20:23], v[50:51], v[182:183], v[20:23]
    v_mfma_f32_16x16x16_bf16 v[16:19], v[52:53], v[184:185], v[16:19]
    v_mfma_f32_16x16x16_bf16 v[20:23], v[52:53], v[186:187], v[20:23]
    v_mfma_f32_16x16x16_bf16 v[16:19], v[54:55], v[188:189], v[16:19]
    v_mfma_f32_16x16x16_bf16 v[20:23], v[54:55], v[190:191], v[20:23]
    s_waitcnt vmcnt(4)
    v_mfma_f32_16x16x32_bf16 v[12:15], v[128:131], v[24:27], 0
    v_mfma_f32_16x16x32_bf16 v[12:15], v[132:135], v[28:31], v[12:15]
    v_mfma_f32_16x16x32_bf16 v[12:15], v[136:139], v[32:35], v[12:15]
    v_mfma_f32_16x16x32_bf16 v[12:15], v[140:143], v[36:39], v[12:15]
    s_nop 7
    v_cvt_pk_bf16_f32 v40, v12, v13
    v_cvt_pk_bf16_f32 v41, v14, v15
    v_lshlrev_b32 v42, 16, v40
    v_and_b32 v43, s77, v40
    v_lshlrev_b32 v44, 16, v41
    v_and_b32 v45, s77, v41
    v_mul_f32 v42, s75, v42
    v_mul_f32 v43, s75, v43
    v_mul_f32 v44, s75, v44
    v_mul_f32 v45, s75, v45
    v_cvt_pk_bf16_f32 v40, v42, v43
    v_cvt_pk_bf16_f32 v41, v44, v45
    v_lshlrev_b32 v42, 16, v40
    v_and_b32 v43, s77, v40
    v_lshlrev_b32 v44, 16, v41
    v_and_b32 v45, s77, v41
    v_max3_f32 v46, v42, v43, v44
    v_max_f32 v46, v46, v45
    v_cmp_gt_f32 vcc, v46, v8
    s_cbranch_vccz L_skip8
    v_max_f32 v46, v46, v8
    v_mov_b32 v47, v46
    s_nop 1
    v_permlane16_swap_b32 v46, v47
    v_max_f32 v46, v46, v47
    v_mov_b32 v47, v46
    s_nop 1
    v_permlane32_swap_b32 v46, v47
    v_max_f32 v8, v46, v47
    v_mul_f32 v47, s76, v8
    v_sub_f32 v46, v9, v47
    v_exp_f32 v46, v46
    v_mov_b32 v9, v47
    v_mul_f32 v10, v10, v46
    v_mov_b32_dpp v47, v46 row_newbcast:0 row_mask:0x1 bank_mask:0xf
    s_nop 1
    v_mov_b32_dpp v47, v46 row_newbcast:4 row_mask:0x2 bank_mask:0xf
    s_nop 1
    v_mov_b32_dpp v47, v46 row_newbcast:8 row_mask:0x4 bank_mask:0xf
    s_nop 1
    v_mov_b32_dpp v47, v46 row_newbcast:12 row_mask:0x8 bank_mask:0xf
    v_mul_f32 v16, v16, v47
    v_mul_f32 v17, v17, v47
    v_mul_f32 v18, v18, v47
    v_mul_f32 v19, v19, v47
    v_mul_f32 v20, v20, v47
    v_mul_f32 v21, v21, v47
    v_mul_f32 v22, v22, v47
    v_mul_f32 v23, v23, v47
L_skip8:
    v_fma_f32 v42, v42, s76, -v9
    v_fma_f32 v43, v43, s76, -v9
    v_fma_f32 v44, v44, s76, -v9
    v_fma_f32 v45, v45, s76, -v9
    v_exp_f32 v42, v42
    v_exp_f32 v43, v43
    v_exp_f32 v44, v44
    v_exp_f32 v45, v45
    v_cvt_pk_bf16_f32 v49, v42, v42
    v_cvt_pk_bf16_f32 v51, v43, v43
    v_cvt_pk_bf16_f32 v53, v44, v44
    v_cvt_pk_bf16_f32 v55, v45, v45
    v_and_b32 v48, v6, v49
    v_and_b32 v49, v7, v49
    v_and_b32 v50, v6, v51
    v_and_b32 v51, v7, v51
    v_and_b32 v52, v6, v53
    v_and_b32 v53, v7, v53
    v_and_b32 v54, v6, v55
    v_and_b32 v55, v7, v55
    v_add_f32 v42, v42, v43
    v_add_f32 v44, v44, v45
    v_add_f32 v10, v10, v42
    v_add_f32 v10, v10, v44
    s_waitcnt vmcnt(0)
    v_mfma_f32_16x16x16_bf16 v[16:19], v[48:49], v[144:145], v[16:19]
    v_mfma_f32_16x16x16_bf16 v[20:23], v[48:49], v[146:147], v[20:23]
    v_mfma_f32_16x16x16_bf16 v[16:19], v[50:51], v[148:149], v[16:19]
    v_mfma_f32_16x16x16_bf16 v[20:23], v[50:51], v[150:151], v[20:23]
    v_mfma_f32_16x16x16_bf16 v[16:19], v[52:53], v[152:153], v[16:19]
    v_mfma_f32_16x16x16_bf16 v[20:23], v[52:53], v[154:155], v[20:23]
    v_mfma_f32_16x16x16_bf16 v[16:19], v[54:55], v[156:157], v[16:19]
    v_mfma_f32_16x16x16_bf16 v[20:23], v[54:55], v[158:159], v[20:23]
L_epi0:
    v_mov_b32 v47, v10
    s_nop 1
    v_permlane16_swap_b32 v10, v47
    v_add_f32 v10, v10, v47
    v_mov_b32 v47, v10
    s_nop 1
    v_permlane32_swap_b32 v10, v47
    v_add_f32 v10, v10, v47
    ds_write_b128 v104, v[16:19] offset:4096
    ds_write_b128 v104, v[20:23] offset:4112
    ds_write2_b32 v105, v9, v10 offset0:0 offset1:32
    s_mov_b64 exec, 1
    ds_add_u32 v4, v5 offset:8
    s_mov_b64 exec, -1
    s_waitcnt lgkmcnt(0)
    s_endpgm
L_help:
    s_cmp_eq_u32 s64, 7
    s_cbranch_scc1 L_h7
    s_waitcnt vmcnt(28)
    v_mfma_f32_16x16x32_bf16 v[12:15], v[128:131], v[24:27], 0
    v_mfma_f32_16x16x32_bf16 v[12:15], v[132:135], v[28:31], v[12:15]
    v_mfma_f32_16x16x32_bf16 v[12:15], v[136:139], v[32:35], v[12:15]
    v_mfma_f32_16x16x32_bf16 v[12:15], v[140:143], v[36:39], v[12:15]
    s_nop 7
    v_cvt_pk_bf16_f32 v40, v12, v13
    v_cvt_pk_bf16_f32 v41, v14, v15
    v_lshlrev_b32 v42, 16, v40
    v_and_b32 v43, s77, v40
    v_lshlrev_b32 v44, 16, v41
    v_and_b32 v45, s77, v41
    v_mul_f32 v42, s75, v42
    v_mul_f32 v43, s75, v43
    v_mul_f32 v44, s75, v44
    v_mul_f32 v45, s75, v45
    v_cvt_pk_bf16_f32 v40, v42, v43
    v_cvt_pk_bf16_f32 v41, v44, v45
    v_lshlrev_b32 v42, 16, v40
    v_and_b32 v43, s77, v40
    v_lshlrev_b32 v44, 16, v41
    v_and_b32 v45, s77, v41
    v_max3_f32 v46, v42, v43, v44
    v_max_f32 v46, v46, v45
    v_cmp_gt_f32 vcc, v46, v8
    s_cbranch_vccz L_skip9
    v_max_f32 v46, v46, v8
    v_mov_b32 v47, v46
    s_nop 1
    v_permlane16_swap_b32 v46, v47
    v_max_f32 v46, v46, v47
    v_mov_b32 v47, v46
    s_nop 1
    v_permlane32_swap_b32 v46, v47
    v_max_f32 v8, v46, v47
    v_mul_f32 v47, s76, v8
    v_sub_f32 v46, v9, v47
    v_exp_f32 v46, v46
    v_mov_b32 v9, v47
    v_mul_f32 v10, v10, v46
    v_mov_b32_dpp v47, v46 row_newbcast:0 row_mask:0x1 bank_mask:0xf
    s_nop 1
    v_mov_b32_dpp v47, v46 row_newbcast:4 row_mask:0x2 bank_mask:0xf
    s_nop 1
    v_mov_b32_dpp v47, v46 row_newbcast:8 row_mask:0x4 bank_mask:0xf
    s_nop 1
    v_mov_b32_dpp v47, v46 row_newbcast:12 row_mask:0x8 bank_mask:0xf
    v_mul_f32 v16, v16, v47
    v_mul_f32 v17, v17, v47
    v_mul_f32 v18, v18, v47
    v_mul_f32 v19, v19, v47
    v_mul_f32 v20, v20, v47
    v_mul_f32 v21, v21, v47
    v_mul_f32 v22, v22, v47
    v_mul_f32 v23, v23, v47
L_skip9:
    v_fma_f32 v42, v42, s76, -v9
    v_fma_f32 v43, v43, s76, -v9
    v_fma_f32 v44, v44, s76, -v9
    v_fma_f32 v45, v45, s76, -v9
    v_exp_f32 v42, v42
    v_exp_f32 v43, v43
    v_exp_f32 v44, v44
    v_exp_f32 v45, v45
    v_cvt_pk_bf16_f32 v49, v42, v42
    v_cvt_pk_bf16_f32 v51, v43, v43
    v_cvt_pk_bf16_f32 v53, v44, v44
    v_cvt_pk_bf16_f32 v55, v45, v45
    v_and_b32 v48, v6, v49
    v_and_b32 v49, v7, v49
    v_and_b32 v50, v6, v51
    v_and_b32 v51, v7, v51
    v_and_b32 v52, v6, v53
    v_and_b32 v53, v7, v53
    v_and_b32 v54, v6, v55
    v_and_b32 v55, v7, v55
    v_add_f32 v42, v42, v43
    v_add_f32 v44, v44, v45
    v_add_f32 v10, v10, v42
    v_add_f32 v10, v10, v44
    s_waitcnt vmcnt(24)
    v_mfma_f32_16x16x16_bf16 v[16:19], v[48:49], v[144:145], v[16:19]
    v_mfma_f32_16x16x16_bf16 v[20:23], v[48:49], v[146:147], v[20:23]
    v_mfma_f32_16x16x16_bf16 v[16:19], v[50:51], v[148:149], v[16:19]
    v_mfma_f32_16x16x16_bf16 v[20:23], v[50:51], v[150:151], v[20:23]
    v_mfma_f32_16x16x16_bf16 v[16:19], v[52:53], v[152:153], v[16:19]
    v_mfma_f32_16x16x16_bf16 v[20:23], v[52:53], v[154:155], v[20:23]
    v_mfma_f32_16x16x16_bf16 v[16:19], v[54:55], v[156:157], v[16:19]
    v_mfma_f32_16x16x16_bf16 v[20:23], v[54:55], v[158:159], v[20:23]
    s_waitcnt vmcnt(12)
    v_mfma_f32_16x16x32_bf16 v[12:15], v[160:163], v[24:27], 0
    v_mfma_f32_16x16x32_bf16 v[12:15], v[164:167], v[28:31], v[12:15]
    v_mfma_f32_16x16x32_bf16 v[12:15], v[168:171], v[32:35], v[12:15]
    v_mfma_f32_16x16x32_bf16 v[12:15], v[172:175], v[36:39], v[12:15]
    s_nop 7
    v_cvt_pk_bf16_f32 v40, v12, v13
    v_cvt_pk_bf16_f32 v41, v14, v15
    v_lshlrev_b32 v42, 16, v40
    v_and_b32 v43, s77, v40
    v_lshlrev_b32 v44, 16, v41
    v_and_b32 v45, s77, v41
    v_mul_f32 v42, s75, v42
    v_mul_f32 v43, s75, v43
    v_mul_f32 v44, s75, v44
    v_mul_f32 v45, s75, v45
    v_cvt_pk_bf16_f32 v40, v42, v43
    v_cvt_pk_bf16_f32 v41, v44, v45
    v_lshlrev_b32 v42, 16, v40
    v_and_b32 v43, s77, v40
    v_lshlrev_b32 v44, 16, v41
    v_and_b32 v45, s77, v41
    v_max3_f32 v46, v42, v43, v44
    v_max_f32 v46, v46, v45
    v_cmp_gt_f32 vcc, v46, v8
    s_cbranch_vccz L_skip10
    v_max_f32 v46, v46, v8
    v_mov_b32 v47, v46
    s_nop 1
    v_permlane16_swap_b32 v46, v47
    v_max_f32 v46, v46, v47
    v_mov_b32 v47, v46
    s_nop 1
    v_permlane32_swap_b32 v46, v47
    v_max_f32 v8, v46, v47
    v_mul_f32 v47, s76, v8
    v_sub_f32 v46, v9, v47
    v_exp_f32 v46, v46
    v_mov_b32 v9, v47
    v_mul_f32 v10, v10, v46
    v_mov_b32_dpp v47, v46 row_newbcast:0 row_mask:0x1 bank_mask:0xf
    s_nop 1
    v_mov_b32_dpp v47, v46 row_newbcast:4 row_mask:0x2 bank_mask:0xf
    s_nop 1
    v_mov_b32_dpp v47, v46 row_newbcast:8 row_mask:0x4 bank_mask:0xf
    s_nop 1
    v_mov_b32_dpp v47, v46 row_newbcast:12 row_mask:0x8 bank_mask:0xf
    v_mul_f32 v16, v16, v47
    v_mul_f32 v17, v17, v47
    v_mul_f32 v18, v18, v47
    v_mul_f32 v19, v19, v47
    v_mul_f32 v20, v20, v47
    v_mul_f32 v21, v21, v47
    v_mul_f32 v22, v22, v47
    v_mul_f32 v23, v23, v47
L_skip10:
    v_fma_f32 v42, v42, s76, -v9
    v_fma_f32 v43, v43, s76, -v9
    v_fma_f32 v44, v44, s76, -v9
    v_fma_f32 v45, v45, s76, -v9
    v_exp_f32 v42, v42
    v_exp_f32 v43, v43
    v_exp_f32 v44, v44
    v_exp_f32 v45, v45
    v_cvt_pk_bf16_f32 v49, v42, v42
    v_cvt_pk_bf16_f32 v51, v43, v43
    v_cvt_pk_bf16_f32 v53, v44, v44
    v_cvt_pk_bf16_f32 v55, v45, v45
    v_and_b32 v48, v6, v49
    v_and_b32 v49, v7, v49
    v_and_b32 v50, v6, v51
    v_and_b32 v51, v7, v51
    v_and_b32 v52, v6, v53
    v_and_b32 v53, v7, v53
    v_and_b32 v54, v6, v55
    v_and_b32 v55, v7, v55
    v_add_f32 v42, v42, v43
    v_add_f32 v44, v44, v45
    v_add_f32 v10, v10, v42
    v_add_f32 v10, v10, v44
    s_waitcnt vmcnt(8)
    v_mfma_f32_16x16x16_bf16 v[16:19], v[48:49], v[176:177], v[16:19]
    v_mfma_f32_16x16x16_bf16 v[20:23], v[48:49], v[178:179], v[20:23]
    v_mfma_f32_16x16x16_bf16 v[16:19], v[50:51], v[180:181], v[16:19]
    v_mfma_f32_16x16x16_bf16 v[20:23], v[50:51], v[182:183], v[20:23]
    v_mfma_f32_16x16x16_bf16 v[16:19], v[52:53], v[184:185], v[16:19]
    v_mfma_f32_16x16x16_bf16 v[20:23], v[52:53], v[186:187], v[20:23]
    v_mfma_f32_16x16x16_bf16 v[16:19], v[54:55], v[188:189], v[16:19]
    v_mfma_f32_16x16x16_bf16 v[20:23], v[54:55], v[190:191], v[20:23]
    s_waitcnt vmcnt(4)
    v_mfma_f32_16x16x32_bf16 v[12:15], v[192:195], v[24:27], 0
    v_mfma_f32_16x16x32_bf16 v[12:15], v[196:199], v[28:31], v[12:15]
    v_mfma_f32_16x16x32_bf16 v[12:15], v[200:203], v[32:35], v[12:15]
    v_mfma_f32_16x16x32_bf16 v[12:15], v[204:207], v[36:39], v[12:15]
    s_nop 7
    v_cvt_pk_bf16_f32 v40, v12, v13
    v_cvt_pk_bf16_f32 v41, v14, v15
    v_lshlrev_b32 v42, 16, v40
    v_and_b32 v43, s77, v40
    v_lshlrev_b32 v44, 16, v41
    v_and_b32 v45, s77, v41
    v_mul_f32 v42, s75, v42
    v_mul_f32 v43, s75, v43
    v_mul_f32 v44, s75, v44
    v_mul_f32 v45, s75, v45
    v_cvt_pk_bf16_f32 v40, v42, v43
    v_cvt_pk_bf16_f32 v41, v44, v45
    v_lshlrev_b32 v42, 16, v40
    v_and_b32 v43, s77, v40
    v_lshlrev_b32 v44, 16, v41
    v_and_b32 v45, s77, v41
    v_max3_f32 v46, v42, v43, v44
    v_max_f32 v46, v46, v45
    v_cmp_gt_f32 vcc, v46, v8
    s_cbranch_vccz L_skip11
    v_max_f32 v46, v46, v8
    v_mov_b32 v47, v46
    s_nop 1
    v_permlane16_swap_b32 v46, v47
    v_max_f32 v46, v46, v47
    v_mov_b32 v47, v46
    s_nop 1
    v_permlane32_swap_b32 v46, v47
    v_max_f32 v8, v46, v47
    v_mul_f32 v47, s76, v8
    v_sub_f32 v46, v9, v47
    v_exp_f32 v46, v46
    v_mov_b32 v9, v47
    v_mul_f32 v10, v10, v46
    v_mov_b32_dpp v47, v46 row_newbcast:0 row_mask:0x1 bank_mask:0xf
    s_nop 1
    v_mov_b32_dpp v47, v46 row_newbcast:4 row_mask:0x2 bank_mask:0xf
    s_nop 1
    v_mov_b32_dpp v47, v46 row_newbcast:8 row_mask:0x4 bank_mask:0xf
    s_nop 1
    v_mov_b32_dpp v47, v46 row_newbcast:12 row_mask:0x8 bank_mask:0xf
    v_mul_f32 v16, v16, v47
    v_mul_f32 v17, v17, v47
    v_mul_f32 v18, v18, v47
    v_mul_f32 v19, v19, v47
    v_mul_f32 v20, v20, v47
    v_mul_f32 v21, v21, v47
    v_mul_f32 v22, v22, v47
    v_mul_f32 v23, v23, v47
L_skip11:
    v_fma_f32 v42, v42, s76, -v9
    v_fma_f32 v43, v43, s76, -v9
    v_fma_f32 v44, v44, s76, -v9
    v_fma_f32 v45, v45, s76, -v9
    v_exp_f32 v42, v42
    v_exp_f32 v43, v43
    v_exp_f32 v44, v44
    v_exp_f32 v45, v45
    v_cvt_pk_bf16_f32 v49, v42, v42
    v_cvt_pk_bf16_f32 v51, v43, v43
    v_cvt_pk_bf16_f32 v53, v44, v44
    v_cvt_pk_bf16_f32 v55, v45, v45
    v_and_b32 v48, v6, v49
    v_and_b32 v49, v7, v49
    v_and_b32 v50, v6, v51
    v_and_b32 v51, v7, v51
    v_and_b32 v52, v6, v53
    v_and_b32 v53, v7, v53
    v_and_b32 v54, v6, v55
    v_and_b32 v55, v7, v55
    v_add_f32 v42, v42, v43
    v_add_f32 v44, v44, v45
    v_add_f32 v10, v10, v42
    v_add_f32 v10, v10, v44
    s_waitcnt vmcnt(0)
    v_mfma_f32_16x16x16_bf16 v[16:19], v[48:49], v[208:209], v[16:19]
    v_mfma_f32_16x16x16_bf16 v[20:23], v[48:49], v[210:211], v[20:23]
    v_mfma_f32_16x16x16_bf16 v[16:19], v[50:51], v[212:213], v[16:19]
    v_mfma_f32_16x16x16_bf16 v[20:23], v[50:51], v[214:215], v[20:23]
    v_mfma_f32_16x16x16_bf16 v[16:19], v[52:53], v[216:217], v[16:19]
    v_mfma_f32_16x16x16_bf16 v[20:23], v[52:53], v[218:219], v[20:23]
    v_mfma_f32_16x16x16_bf16 v[16:19], v[54:55], v[220:221], v[16:19]
    v_mfma_f32_16x16x16_bf16 v[20:23], v[54:55], v[222:223], v[20:23]
    v_mov_b32 v47, v10
    s_nop 1
    v_permlane16_swap_b32 v10, v47
    v_add_f32 v10, v10, v47
    v_mov_b32 v47, v10
    s_nop 1
    v_permlane32_swap_b32 v10, v47
    v_add_f32 v10, v10, v47
    ds_write_b128 v104, v[16:19] offset:4096
    ds_write_b128 v104, v[20:23] offset:4112
    ds_write2_b32 v105, v9, v10 offset0:0 offset1:32
L_h7:
L_epi:
    s_mov_b32 s16, 0x0fff0fff
    s_mov_b32 s17, 0x05040100
    s_mov_b32 s18, 0xfff
    s_mov_b32 s19, 0x07060302
    s_waitcnt vmcnt(0) lgkmcnt(0)
    v_perm_b32 v107, v106, v106, s17
    s_and_b32 s71, s64, 3
    s_lshl_b32 s72, s71, 13
    s_add_u32 s72, s72, 0x5000
    v_lshrrev_b32 v53, 2, v127
    v_and_b32 v53, 0xfc00, v53
    v_and_b32 v54, 0x70, v127
    v_or_b32 v53, v53, v54
    v_add_u32 v53, s72, v53
    ds_write_b128 v53, v[56:59] offset:0
    ds_write_b128 v53, v[60:63] offset:256
    ds_write_b128 v53, v[64:67] offset:512
    ds_write_b128 v53, v[68:71] offset:768
    ds_write_b128 v53, v[72:75] offset:128
    ds_write_b128 v53, v[76:79] offset:384
    ds_write_b128 v53, v[80:83] offset:640
    ds_write_b128 v53, v[84:87] offset:896
    v_lshrrev_b32 v53, 4, v0
    v_lshlrev_b32 v53, 11, v53
    v_bfe_u32 v54, v0, 2, 2
    v_lshlrev_b32 v54, 6, v54
    v_or_b32 v53, v53, v54
    v_and_b32 v54, 3, v0
    v_lshlrev_b32 v54, 1, v54
    v_or_b32 v53, v53, v54
    v_add_u32 v53, s72, v53
    s_waitcnt lgkmcnt(0)
    ds_read_u16 v128, v53 offset:0
    ds_read_u16 v129, v53 offset:512
    ds_read_u16 v130, v53 offset:1024
    ds_read_u16 v131, v53 offset:1536
    ds_read_u16 v132, v53 offset:8
    ds_read_u16 v133, v53 offset:520
    ds_read_u16 v134, v53 offset:1032
    ds_read_u16 v135, v53 offset:1544
    ds_read_u16 v136, v53 offset:16
    ds_read_u16 v137, v53 offset:528
    ds_read_u16 v138, v53 offset:1040
    ds_read_u16 v139, v53 offset:1552
    ds_read_u16 v140, v53 offset:24
    ds_read_u16 v141, v53 offset:536
    ds_read_u16 v142, v53 offset:1048
    ds_read_u16 v143, v53 offset:1560
    s_waitcnt lgkmcnt(0)
    ds_read_u16 v144, v53 offset:32
    ds_read_u16 v145, v53 offset:544
    ds_read_u16 v146, v53 offset:1056
    ds_read_u16 v147, v53 offset:1568
    ds_read_u16 v148, v53 offset:40
    ds_read_u16 v149, v53 offset:552
    ds_read_u16 v150, v53 offset:1064
    ds_read_u16 v151, v53 offset:1576
    ds_read_u16 v152, v53 offset:48
    ds_read_u16 v153, v53 offset:560
    ds_read_u16 v154, v53 offset:1072
    ds_read_u16 v155, v53 offset:1584
    ds_read_u16 v156, v53 offset:56
    ds_read_u16 v157, v53 offset:568
    ds_read_u16 v158, v53 offset:1080
    ds_read_u16 v159, v53 offset:1592
    s_waitcnt lgkmcnt(0)
    ds_read_u16 v160, v53 offset:256
    ds_read_u16 v161, v53 offset:768
    ds_read_u16 v162, v53 offset:1280
    ds_read_u16 v163, v53 offset:1792
    ds_read_u16 v164, v53 offset:264
    ds_read_u16 v165, v53 offset:776
    ds_read_u16 v166, v53 offset:1288
    ds_read_u16 v167, v53 offset:1800
    ds_read_u16 v168, v53 offset:272
    ds_read_u16 v169, v53 offset:784
    ds_read_u16 v170, v53 offset:1296
    ds_read_u16 v171, v53 offset:1808
    ds_read_u16 v172, v53 offset:280
    ds_read_u16 v173, v53 offset:792
    ds_read_u16 v174, v53 offset:1304
    ds_read_u16 v175, v53 offset:1816
    s_waitcnt lgkmcnt(0)
    ds_read_u16 v176, v53 offset:288
    ds_read_u16 v177, v53 offset:800
    ds_read_u16 v178, v53 offset:1312
    ds_read_u16 v179, v53 offset:1824
    ds_read_u16 v180, v53 offset:296
    ds_read_u16 v181, v53 offset:808
    ds_read_u16 v182, v53 offset:1320
    ds_read_u16 v183, v53 offset:1832
    ds_read_u16 v184, v53 offset:304
    ds_read_u16 v185, v53 offset:816
    ds_read_u16 v186, v53 offset:1328
    ds_read_u16 v187, v53 offset:1840
    ds_read_u16 v188, v53 offset:312
    ds_read_u16 v189, v53 offset:824
    ds_read_u16 v190, v53 offset:1336
    ds_read_u16 v191, v53 offset:1848
    s_waitcnt lgkmcnt(0)
    v_lshl_or_b32 v128, v160, 16, v128
    v_lshl_or_b32 v129, v161, 16, v129
    v_lshl_or_b32 v130, v162, 16, v130
    v_lshl_or_b32 v131, v163, 16, v131
    v_lshl_or_b32 v132, v164, 16, v132
    v_lshl_or_b32 v133, v165, 16, v133
    v_lshl_or_b32 v134, v166, 16, v134
    v_lshl_or_b32 v135, v167, 16, v135
    v_lshl_or_b32 v136, v168, 16, v136
    v_lshl_or_b32 v137, v169, 16, v137
    v_lshl_or_b32 v138, v170, 16, v138
    v_lshl_or_b32 v139, v171, 16, v139
    v_lshl_or_b32 v140, v172, 16, v140
    v_lshl_or_b32 v141, v173, 16, v141
    v_lshl_or_b32 v142, v174, 16, v142
    v_lshl_or_b32 v143, v175, 16, v143
    v_lshl_or_b32 v144, v176, 16, v144
    v_lshl_or_b32 v145, v177, 16, v145
    v_lshl_or_b32 v146, v178, 16, v146
    v_lshl_or_b32 v147, v179, 16, v147
    v_lshl_or_b32 v148, v180, 16, v148
    v_lshl_or_b32 v149, v181, 16, v149
    v_lshl_or_b32 v150, v182, 16, v150
    v_lshl_or_b32 v151, v183, 16, v151
    v_lshl_or_b32 v152, v184, 16, v152
    v_lshl_or_b32 v153, v185, 16, v153
    v_lshl_or_b32 v154, v186, 16, v154
    v_lshl_or_b32 v155, v187, 16, v155
    v_lshl_or_b32 v156, v188, 16, v156
    v_lshl_or_b32 v157, v189, 16, v157
    v_lshl_or_b32 v158, v190, 16, v158
    v_lshl_or_b32 v159, v191, 16, v159
    v_mov_b32 v160, 0
    v_mov_b32 v161, 0
    v_mov_b32 v162, 0
    v_mov_b32 v163, 0
    v_mov_b32 v164, 0
    v_mov_b32 v165, 0
    v_mov_b32 v166, 0
    v_mov_b32 v167, 0
    v_mov_b32 v168, 0
    v_mov_b32 v169, 0
    v_mov_b32 v170, 0
    v_mov_b32 v171, 0
    v_mov_b32 v172, 0
    v_mov_b32 v173, 0
    v_mov_b32 v174, 0
    v_mov_b32 v175, 0
    v_mov_b32 v176, 0
    v_mov_b32 v177, 0
    v_mov_b32 v178, 0
    v_mov_b32 v179, 0
    v_mov_b32 v180, 0
    v_mov_b32 v181, 0
    v_mov_b32 v182, 0
    v_mov_b32 v183, 0
    v_mov_b32 v184, 0
    v_mov_b32 v185, 0
    v_mov_b32 v186, 0
    v_mov_b32 v187, 0
    v_mov_b32 v188, 0
    v_mov_b32 v189, 0
    v_mov_b32 v190, 0
    v_mov_b32 v191, 0
    s_mov_b32 s10, 0x10001
    s_mov_b32 s11, 0x10001
    v_and_b32 v53, 48, v0
    v_lshlrev_b32 v52, 10, v53
    v_bfe_u32 v54, v0, 2, 1
    v_lshlrev_b32 v54, 13, v54
    v_or_b32 v52, v52, v54
    v_and_b32 v54, 3, v0
    v_lshlrev_b32 v54, 4, v54
    v_or_b32 v52, v52, v54
    s_lshl_b32 s71, s71, 16
    v_add_u32 v52, s71, v52
    s_sub_u32 s71, s85, 2097152
    s_and_b32 s72, s71, 0x7ff
    s_mul_i32 s72, s72, 3
    s_add_u32 s85, s85, s72
    s_waitcnt lgkmcnt(0)
    s_lshl_b32 s21, s65, 3
    s_and_b32 s72, s2, 7
    s_add_u32 s21, s21, s72
    s_lshl_b32 s20, s21, 2
    s_and_b32 s72, s64, 3
    s_add_u32 s20, s20, s72
    s_lshl_b32 s20, s20, 11
    s_add_u32 s20, s20, 2097152
    s_lshl_b32 s21, s21, 5
    v_lshrrev_b32 v55, 4, v0
    v_lshlrev_b32 v55, 1, v55
    v_and_b32 v54, 3, v0
    v_lshlrev_b32 v54, 3, v54
    v_or_b32 v55, v55, v54
    v_lshlrev_b32 v109, 3, v55
    s_lshl_b32 s72, s72, 2
    v_add_u32 v50, s72, v109
    s_mov_b64 s[22:23], -1
    s_mov_b64 s[24:25], -1
    v_mov_b32 v240, 0
    v_mov_b32 v241, 0
    v_mov_b32 v242, 0
    v_mov_b32 v243, 0
    s_cmp_lt_u32 s64, 6
    s_cbranch_scc1 L_merge
    s_cmp_eq_u32 s64, 6
    s_cbranch_scc1 L_comb
    s_setprio 0
    s_barrier
    s_branch L_b4
L_comb:
    s_cmp_ge_u32 s66, 16
    s_cselect_b32 s72, 30, 0
    s_cselect_b64 s[88:89], 0xffff, -1
    s_cselect_b64 s[90:91], 0, -1
    s_cselect_b64 s[96:97], 0, -1
    s_cselect_b32 s98, 0, -1
    s_cselect_b32 s99, 0, 0xffff
    s_lshl_b32 s9, s65, 5
    s_add_u32 s9, s9, s72
    s_lshl_b32 s9, s9, 12
    s_add_u32 s9, s9, 65536
    s_lshl_b32 s8, s65, 12
    s_lshl_b32 s71, s66, 7
    s_and_b32 s71, s71, 0xe00
    s_add_u32 s8, s8, s71
    s_add_u32 s8, s8, 1572864
    s_and_b32 s72, s66, 15
    s_lshl_b32 s72, s72, 7
    s_add_u32 s4, s9, s72
    s_add_u32 s5, s4, 32768
    s_add_u32 s6, s4, 65536
    s_add_u32 s7, s4, 98304
    v_lshrrev_b32 v41, 8, v127
    v_mov_b32 v192, 0
    v_mov_b32 v193, 0
    v_mov_b32 v194, 0
    v_mov_b32 v195, 0
    v_mov_b32 v196, 0
    v_mov_b32 v197, 0
    v_mov_b32 v198, 0
    v_mov_b32 v199, 0
    v_mov_b32 v200, 0
    v_mov_b32 v201, 0
    v_mov_b32 v202, 0
    v_mov_b32 v203, 0
    v_mov_b32 v204, 0
    v_mov_b32 v205, 0
    v_mov_b32 v206, 0
    v_mov_b32 v207, 0
    v_mov_b32 v208, 0xff800000
    v_mov_b32 v209, 0
    v_mov_b32 v210, 0
    v_mov_b32 v212, 0xff800000
    v_mov_b32 v213, 0
    v_mov_b32 v214, 0
    v_mov_b32 v216, 0xff800000
    v_mov_b32 v217, 0
    v_mov_b32 v218, 0
    v_mov_b32 v220, 0xff800000
    v_mov_b32 v221, 0
    v_mov_b32 v222, 0
    v_and_b32 v40, 7, v0
    v_lshlrev_b32 v40, 3, v40
    v_lshrrev_b32 v54, 4, v0
    v_lshlrev_b32 v54, 1, v54
    v_or_b32 v40, v40, v54
    s_mov_b32 s74, 400000
    s_setprio 0
    s_barrier
L_fw:
    ds_read_b32 v49, v4 offset:8
    s_waitcnt lgkmcnt(0)
    v_cmp_gt_u32 vcc, 4, v49
    s_cbranch_vccz L_fwd
    s_sub_u32 s74, s74, 1
    s_cbranch_scc0 L_fw
L_fwd:
    s_mov_b32 s74, 400000
L_l1poll:
    s_mov_b64 exec, s[88:89]
    buffer_load_dwordx4 v[192:195], v127, s[52:55], s4 offen sc1
    buffer_load_dwordx4 v[208:211], v41, s[52:55], s8 offen offset:0 sc1
    s_mov_b64 exec, s[90:91]
    buffer_load_dwordx4 v[196:199], v127, s[52:55], s5 offen sc1
    buffer_load_dwordx4 v[212:215], v41, s[52:55], s8 offen offset:128 sc1
    s_mov_b64 exec, s[96:97]
    buffer_load_dwordx4 v[200:203], v127, s[52:55], s6 offen sc1
    buffer_load_dwordx4 v[216:219], v41, s[52:55], s8 offen offset:256 sc1
    s_mov_b64 exec, s[98:99]
    buffer_load_dwordx4 v[204:207], v127, s[52:55], s7 offen sc1
    buffer_load_dwordx4 v[220:223], v41, s[52:55], s8 offen offset:384 sc1
    s_mov_b64 exec, s[88:89]
    s_waitcnt vmcnt(7)
    v_perm_b32 v42, v193, v192, s17
    v_perm_b32 v43, v195, v194, s17
    v_bitop3_b32 v42, v42, v43, v107 bitop3:0x7e
    s_waitcnt vmcnt(6)
    v_perm_b32 v44, v209, v208, s17
    v_perm_b32 v43, v211, v210, s17
    v_bitop3_b32 v44, v44, v43, v107 bitop3:0x7e
    v_bitop3_b32 v42, v42, v44, s16 bitop3:0xa8
    v_cmp_ne_u32 s[88:89], 0, v42
    s_mov_b64 exec, s[90:91]
    s_waitcnt vmcnt(5)
    v_perm_b32 v42, v197, v196, s17
    v_perm_b32 v43, v199, v198, s17
    v_bitop3_b32 v42, v42, v43, v107 bitop3:0x7e
    s_waitcnt vmcnt(4)
    v_perm_b32 v44, v213, v212, s17
    v_perm_b32 v43, v215, v214, s17
    v_bitop3_b32 v44, v44, v43, v107 bitop3:0x7e
    v_bitop3_b32 v42, v42, v44, s16 bitop3:0xa8
    v_cmp_ne_u32 s[90:91], 0, v42
    s_mov_b64 exec, s[96:97]
    s_waitcnt vmcnt(3)
    v_perm_b32 v42, v201, v200, s17
    v_perm_b32 v43, v203, v202, s17
    v_bitop3_b32 v42, v42, v43, v107 bitop3:0x7e
    s_waitcnt vmcnt(2)
    v_perm_b32 v44, v217, v216, s17
    v_perm_b32 v43, v219, v218, s17
    v_bitop3_b32 v44, v44, v43, v107 bitop3:0x7e
    v_bitop3_b32 v42, v42, v44, s16 bitop3:0xa8
    v_cmp_ne_u32 s[96:97], 0, v42
    s_mov_b64 exec, s[98:99]
    s_waitcnt vmcnt(1)
    v_perm_b32 v42, v205, v204, s17
    v_perm_b32 v43, v207, v206, s17
    v_bitop3_b32 v42, v42, v43, v107 bitop3:0x7e
    s_waitcnt vmcnt(0)
    v_perm_b32 v44, v221, v220, s17
    v_perm_b32 v43, v223, v222, s17
    v_bitop3_b32 v44, v44, v43, v107 bitop3:0x7e
    v_bitop3_b32 v42, v42, v44, s16 bitop3:0xa8
    v_cmp_ne_u32 s[98:99], 0, v42
    s_or_b64 s[12:13], s[88:89], s[90:91]
    s_or_b64 s[14:15], s[96:97], s[98:99]
    s_or_b64 s[12:13], s[12:13], s[14:15]
    s_cbranch_scc0 L_l1done
    s_sub_u32 s74, s74, 1
    s_cbranch_scc0 L_l1poll
L_l1done:
    s_mov_b64 exec, -1
    v_perm_b32 v208, v208, v209, s19
    v_perm_b32 v212, v212, v213, s19
    v_perm_b32 v216, v216, v217, s19
    v_perm_b32 v220, v220, v221, s19
    v_max3_f32 v42, v208, v212, v216
    v_max_f32 v42, v42, v220
    s_nop 1
    v_max_f32_dpp v42, v42, v42 row_ror:8 row_mask:0xf bank_mask:0xf
    v_mov_b32 v43, v42
    s_nop 1
    v_permlane16_swap_b32 v42, v43
    v_max_f32 v42, v42, v43
    v_mov_b32 v43, v42
    s_nop 1
    v_permlane32_swap_b32 v42, v43
    v_max_f32 v42, v42, v43
    v_sub_f32 v208, v208, v42
    v_sub_f32 v212, v212, v42
    v_sub_f32 v216, v216, v42
    v_sub_f32 v220, v220, v42
    v_exp_f32 v208, v208
    v_exp_f32 v212, v212
    v_exp_f32 v216, v216
    v_exp_f32 v220, v220
    v_mul_f32 v43, v208, v210
    v_mul_f32 v44, v208, v192
    v_mul_f32 v45, v208, v193
    v_mul_f32 v46, v208, v194
    v_mul_f32 v47, v208, v195
    v_fmac_f32 v43, v212, v214
    v_fmac_f32 v44, v212, v196
    v_fmac_f32 v45, v212, v197
    v_fmac_f32 v46, v212, v198
    v_fmac_f32 v47, v212, v199
    v_fmac_f32 v43, v216, v218
    v_fmac_f32 v44, v216, v200
    v_fmac_f32 v45, v216, v201
    v_fmac_f32 v46, v216, v202
    v_fmac_f32 v47, v216, v203
    v_fmac_f32 v43, v220, v222
    v_fmac_f32 v44, v220, v204
    v_fmac_f32 v45, v220, v205
    v_fmac_f32 v46, v220, v206
    v_fmac_f32 v47, v220, v207
    v_mov_b32 v42, v43
    v_permlane32_swap_b32 v44, v46
    v_permlane32_swap_b32 v45, v47
    v_permlane32_swap_b32 v42, v43
    v_add_f32 v44, v44, v46
    v_add_f32 v45, v45, v47
    v_add_f32 v43, v42, v43
    v_mov_b32 v42, v43
    v_permlane16_swap_b32 v44, v45
    s_nop 0
    v_permlane16_swap_b32 v42, v43
    v_add_f32 v44, v44, v45
    v_add_f32 v43, v42, v43
    s_nop 0
    v_add_f32_dpp v44, v44, v44 row_ror:8 row_mask:0xf bank_mask:0xf
    v_add_f32_dpp v43, v43, v43 row_ror:8 row_mask:0xf bank_mask:0xf
    v_rcp_f32 v43, v43
    s_nop 0
    v_mul_f32 v44, v44, v43
    v_cvt_pk_bf16_f32 v44, v44, v44
    ds_write_b16 v40, v44 offset:3328
    s_waitcnt lgkmcnt(0)
    s_branch L_b4
L_merge:
    s_and_b32 s72, s64, 1
    s_lshl_b32 s71, s72, 10
    v_add_u32 v40, s71, v2
    v_lshrrev_b32 v41, 5, v0
    s_lshl_b32 s72, s72, 1
    v_add_u32 v48, s72, v41
    v_lshlrev_b32 v41, 5, v48
    v_lshlrev_b32 v48, 9, v48
    v_mov_b32 v59, v106
    s_mov_b32 s74, 400000
    s_setprio 0
    s_barrier
    ds_read_b128 v[28:31], v41 offset:3088
    ds_read_b128 v[36:39], v41 offset:3216
    ds_read_b128 v[208:211], v40 offset:12288
    ds_read_b128 v[212:215], v40 offset:14336
    ds_read_b128 v[216:219], v40 offset:16384
    s_waitcnt lgkmcnt(4)
    v_max3_f32 v42, v28, v29, v30
    v_sub_f32 v28, v28, v42
    v_sub_f32 v29, v29, v42
    v_sub_f32 v30, v30, v42
    v_exp_f32 v28, v28
    v_exp_f32 v29, v29
    v_exp_f32 v30, v30
    s_waitcnt lgkmcnt(0)
    v_mul_f32 v36, v28, v36
    v_fmac_f32 v36, v29, v37
    v_fmac_f32 v36, v30, v38
    v_mul_f32 v208, v28, v208
    v_fmac_f32 v208, v29, v212
    v_fmac_f32 v208, v30, v216
    v_mul_f32 v209, v28, v209
    v_fmac_f32 v209, v29, v213
    v_fmac_f32 v209, v30, v217
    v_mul_f32 v210, v28, v210
    v_fmac_f32 v210, v29, v214
    v_fmac_f32 v210, v30, v218
    v_mul_f32 v211, v28, v211
    v_fmac_f32 v211, v29, v215
    v_fmac_f32 v211, v30, v219
    v_mov_b32 v28, v42
L_fspin:
    ds_read_b32 v49, v4 offset:8
    ds_read_b128 v[24:27], v41 offset:3072
    ds_read_b128 v[32:35], v41 offset:3200
    ds_read_b128 v[192:195], v40 offset:4096
    ds_read_b128 v[196:199], v40 offset:6144
    ds_read_b128 v[200:203], v40 offset:8192
    ds_read_b128 v[204:207], v40 offset:10240
    s_waitcnt lgkmcnt(6)
    v_cmp_ne_u32 vcc, 4, v49
    s_cbranch_vccz L_fdone
    s_waitcnt lgkmcnt(0)
    s_sub_u32 s74, s74, 1
    s_cbranch_scc0 L_fspin
L_fdone:
    s_waitcnt lgkmcnt(5)
    v_max3_f32 v42, v24, v25, v26
    v_max3_f32 v42, v42, v27, v28
    v_sub_f32 v24, v24, v42
    v_sub_f32 v25, v25, v42
    v_sub_f32 v26, v26, v42
    v_sub_f32 v27, v27, v42
    v_sub_f32 v28, v28, v42
    v_exp_f32 v24, v24
    v_exp_f32 v25, v25
    v_exp_f32 v26, v26
    v_exp_f32 v27, v27
    v_exp_f32 v28, v28
    v_bfi_b32 v56, s77, v42, v107
    v_perm_b32 v57, v42, v107, s17
    s_waitcnt lgkmcnt(4)
    v_mul_f32 v43, v28, v36
    v_mul_f32 v44, v28, v208
    v_mul_f32 v45, v28, v209
    v_mul_f32 v46, v28, v210
    v_mul_f32 v47, v28, v211
    v_fmac_f32 v43, v24, v32
    v_fmac_f32 v43, v25, v33
    v_fmac_f32 v43, v26, v34
    v_fmac_f32 v43, v27, v35
    s_waitcnt lgkmcnt(3)
    v_fmac_f32 v44, v24, v192
    v_fmac_f32 v45, v24, v193
    v_fmac_f32 v46, v24, v194
    v_fmac_f32 v47, v24, v195
    s_waitcnt lgkmcnt(2)
    v_fmac_f32 v44, v25, v196
    v_fmac_f32 v45, v25, v197
    v_fmac_f32 v46, v25, v198
    v_fmac_f32 v47, v25, v199
    s_waitcnt lgkmcnt(1)
    v_fmac_f32 v44, v26, v200
    v_fmac_f32 v45, v26, v201
    v_fmac_f32 v46, v26, v202
    v_fmac_f32 v47, v26, v203
    s_waitcnt lgkmcnt(0)
    v_fmac_f32 v44, v27, v204
    v_fmac_f32 v45, v27, v205
    v_fmac_f32 v46, v27, v206
    v_fmac_f32 v47, v27, v207
    v_bfi_b32 v58, s18, v107, v43
    v_bfi_b32 v44, s18, v107, v44
    v_bfi_b32 v45, s18, v107, v45
    v_bfi_b32 v46, s18, v107, v46
    v_bfi_b32 v47, s18, v107, v47
    buffer_store_dwordx4 v[44:47], v40, s[52:55], s84 offen sc1
    s_mov_b32 exec_lo, 1
    s_mov_b32 exec_hi, 1
    buffer_store_dwordx4 v[56:59], v48, s[52:55], s87 offen sc1
    s_mov_b64 exec, -1
L_b4:
    s_barrier
    s_lshl_b64 exec, s[10:11], 0
    ds_read_b128 v[160:163], v53 offset:3328
    s_lshl_b64 exec, s[10:11], 1
    ds_read_b128 v[164:167], v53 offset:3328
    s_lshl_b64 exec, s[10:11], 2
    ds_read_b128 v[168:171], v53 offset:3328
    s_lshl_b64 exec, s[10:11], 3
    ds_read_b128 v[172:175], v53 offset:3328
    s_lshl_b64 exec, s[10:11], 4
    ds_read_b128 v[176:179], v53 offset:3328
    s_lshl_b64 exec, s[10:11], 5
    ds_read_b128 v[180:183], v53 offset:3328
    s_lshl_b64 exec, s[10:11], 6
    ds_read_b128 v[184:187], v53 offset:3328
    s_lshl_b64 exec, s[10:11], 7
    ds_read_b128 v[188:191], v53 offset:3328
    s_mov_b64 exec, -1
    s_waitcnt lgkmcnt(7)
    v_mfma_f32_16x16x32_bf16 v[44:47], v[128:131], v[160:163], 0
    s_waitcnt lgkmcnt(6)
    v_mfma_f32_16x16x32_bf16 v[44:47], v[132:135], v[164:167], v[44:47]
    s_waitcnt lgkmcnt(5)
    v_mfma_f32_16x16x32_bf16 v[44:47], v[136:139], v[168:171], v[44:47]
    s_waitcnt lgkmcnt(4)
    v_mfma_f32_16x16x32_bf16 v[44:47], v[140:143], v[172:175], v[44:47]
    s_waitcnt lgkmcnt(3)
    v_mfma_f32_16x16x32_bf16 v[44:47], v[144:147], v[176:179], v[44:47]
    s_waitcnt lgkmcnt(2)
    v_mfma_f32_16x16x32_bf16 v[44:47], v[148:151], v[180:183], v[44:47]
    s_waitcnt lgkmcnt(1)
    v_mfma_f32_16x16x32_bf16 v[44:47], v[152:155], v[184:187], v[44:47]
    s_waitcnt lgkmcnt(0)
    v_mfma_f32_16x16x32_bf16 v[44:47], v[156:159], v[188:191], v[44:47]
    s_nop 7
    v_bfi_b32 v44, s18, v107, v44
    v_bfi_b32 v45, s18, v107, v45
    v_bfi_b32 v46, s18, v107, v46
    v_bfi_b32 v47, s18, v107, v47
    s_mov_b32 exec_lo, 0xff00ff
    s_mov_b32 exec_hi, 0xff00ff
    buffer_store_dwordx4 v[44:47], v52, s[52:55], s85 offen sc1
    s_mov_b64 exec, -1
    s_and_b32 s72, s2, 24
    s_cbranch_scc0 L_red
    s_lshl_b32 s71, s2, 3
    s_add_u32 s71, s71, s64
    s_cmp_eq_u32 s71, 68
    s_cbranch_scc0 L_fin
    s_mov_b32 s4, 2097152
    s_mov_b64 s[88:89], -1
    s_mov_b32 s5, 2101248
    s_mov_b64 s[90:91], -1
    s_mov_b32 s6, 2359296
    s_mov_b64 s[96:97], -1
    s_mov_b32 s7, 2363392
    s_mov_b64 s[98:99], -1
    v_lshlrev_b32 v2, 6, v0
    s_mov_b32 s74, 400000
L_eppoll:
    s_mov_b64 exec, s[88:89]
    buffer_load_dwordx4 v[24:27], v2, s[52:55], s4 offen sc1
    s_mov_b64 exec, s[90:91]
    buffer_load_dwordx4 v[28:31], v2, s[52:55], s5 offen sc1
    s_mov_b64 exec, s[96:97]
    buffer_load_dwordx4 v[32:35], v2, s[52:55], s6 offen sc1
    s_mov_b64 exec, s[98:99]
    buffer_load_dwordx4 v[36:39], v2, s[52:55], s7 offen sc1
    s_mov_b64 exec, s[88:89]
    s_waitcnt vmcnt(3)
    v_perm_b32 v42, v25, v24, s17
    v_perm_b32 v43, v27, v26, s17
    v_bitop3_b32 v42, v42, v43, v107 bitop3:0x7e
    v_and_b32 v42, s16, v42
    v_cmp_ne_u32 s[88:89], 0, v42
    s_mov_b64 exec, s[90:91]
    s_waitcnt vmcnt(2)
    v_perm_b32 v42, v29, v28, s17
    v_perm_b32 v43, v31, v30, s17
    v_bitop3_b32 v42, v42, v43, v107 bitop3:0x7e
    v_and_b32 v42, s16, v42
    v_cmp_ne_u32 s[90:91], 0, v42
    s_mov_b64 exec, s[96:97]
    s_waitcnt vmcnt(1)
    v_perm_b32 v42, v33, v32, s17
    v_perm_b32 v43, v35, v34, s17
    v_bitop3_b32 v42, v42, v43, v107 bitop3:0x7e
    v_and_b32 v42, s16, v42
    v_cmp_ne_u32 s[96:97], 0, v42
    s_mov_b64 exec, s[98:99]
    s_waitcnt vmcnt(0)
    v_perm_b32 v42, v37, v36, s17
    v_perm_b32 v43, v39, v38, s17
    v_bitop3_b32 v42, v42, v43, v107 bitop3:0x7e
    v_and_b32 v42, s16, v42
    v_cmp_ne_u32 s[98:99], 0, v42
    s_or_b64 s[12:13], s[88:89], s[90:91]
    s_or_b64 s[14:15], s[96:97], s[98:99]
    s_or_b64 s[12:13], s[12:13], s[14:15]
    s_cbranch_scc0 L_epdone
    s_sub_u32 s74, s74, 1
    s_cbranch_scc0 L_eppoll
L_epdone:
    s_mov_b64 exec, 1
    buffer_store_dword v106, v4, s[52:55], 0 offen sc1
    s_mov_b64 exec, -1
    s_branch L_fin
L_red:
    s_mov_b32 s74, 400000
    buffer_load_dwordx4 v[192:195], v2, s[52:55], s20 offen offset:0 sc1
    buffer_load_dwordx4 v[196:199], v2, s[52:55], s20 offen offset:1024 sc1
L_l2poll:
    s_mov_b64 exec, s[22:23]
    s_waitcnt vmcnt(1)
    v_perm_b32 v42, v193, v192, s17
    v_perm_b32 v43, v195, v194, s17
    v_bitop3_b32 v42, v42, v43, v107 bitop3:0x7e
    v_and_b32 v42, s16, v42
    v_cmp_ne_u32 s[22:23], 0, v42
    s_andn2_b64 exec, exec, s[22:23]
    v_add_f32 v240, v240, v192
    v_add_f32 v241, v241, v193
    v_add_f32 v242, v242, v194
    v_add_f32 v243, v243, v195
    s_or_b64 s[12:13], s[22:23], s[24:25]
    s_cbranch_scc0 L_l2done
    s_mov_b64 exec, s[22:23]
    buffer_load_dwordx4 v[192:195], v2, s[52:55], s20 offen offset:0 sc1
    s_mov_b64 exec, s[24:25]
    s_waitcnt vmcnt(1)
    v_perm_b32 v42, v197, v196, s17
    v_perm_b32 v43, v199, v198, s17
    v_bitop3_b32 v42, v42, v43, v107 bitop3:0x7e
    v_and_b32 v42, s16, v42
    v_cmp_ne_u32 s[24:25], 0, v42
    s_andn2_b64 exec, exec, s[24:25]
    v_add_f32 v240, v240, v196
    v_add_f32 v241, v241, v197
    v_add_f32 v242, v242, v198
    v_add_f32 v243, v243, v199
    s_or_b64 s[12:13], s[22:23], s[24:25]
    s_cbranch_scc0 L_l2done
    s_mov_b64 exec, s[24:25]
    buffer_load_dwordx4 v[196:199], v2, s[52:55], s20 offen offset:1024 sc1
    s_sub_u32 s74, s74, 1
    s_cbranch_scc0 L_l2poll
L_l2done:
    s_mov_b64 exec, -1
    v_permlane32_swap_b32 v240, v242
    v_permlane32_swap_b32 v241, v243
    v_add_f32 v24, v240, v242
    v_add_f32 v25, v241, v243
    s_nop 1
    v_permlane16_swap_b32 v24, v25
    v_add_f32 v24, v24, v25
    s_nop 1
    v_add_f32_dpp v24, v24, v24 row_ror:8 row_mask:0xf bank_mask:0xf
    s_nop 1
    v_add_f32_dpp v24, v24, v24 row_ror:4 row_mask:0xf bank_mask:0xf
    ds_write_b32 v50, v24 offset:3584
    s_waitcnt lgkmcnt(0)
    s_barrier
    s_cmp_eq_u32 s64, 7
    s_cbranch_scc0 L_fin
    ds_read_b128 v[24:27], v109 offset:3584
    s_waitcnt lgkmcnt(0)
    v_add_f32 v24, v24, v25
    v_add_f32 v26, v26, v27
    v_add_f32 v24, v24, v26
    v_cvt_pk_bf16_f32 v24, v24, v24
    s_mov_b32 exec_lo, 0xf000f
    s_mov_b32 exec_hi, 0xf000f
    buffer_store_short v24, v55, s[60:63], s21 offen
    s_mov_b64 exec, -1
L_fin:
    s_waitcnt vmcnt(0)
L_end:
    s_endpgm
.section .rodata,"a"
.p2align 6
.amdhsa_kernel concat_heads__gqa_block_cached__sliding_block_cached__decode_kernel
  .amdhsa_next_free_vgpr 256
  .amdhsa_next_free_sgpr 102
  .amdhsa_accum_offset 256
  .amdhsa_group_segment_fixed_size 0
  .amdhsa_kernarg_size 104
  .amdhsa_user_sgpr_count 2
  .amdhsa_user_sgpr_kernarg_segment_ptr 1
  .amdhsa_system_sgpr_workgroup_id_x 1
.end_amdhsa_kernel
```
